```python
import torch

def _softmax(x, axis=-1):
    return torch.softmax(x, dim=axis)
def _gelu(x):
    return torch.nn.functional.gelu(x, approximate="tanh")
def _silu(x):
    return torch.nn.functional.silu(x)
def _sigmoid(x):
    return torch.sigmoid(x)
def _layernorm(x, axis=-1, eps=1e-5):
    m = x.mean(dim=axis, keepdim=True)
    v = x.var(dim=axis, keepdim=True, unbiased=False)
    return (x - m) / torch.sqrt(v + eps)
def _scatter_add(tgt, idx, src, axis=0):
    return tgt.clone().index_add_(axis, idx, src)
def _segment_sum(src, seg, n):
    out = torch.zeros((n,) + src.shape[1:], dtype=src.dtype)
    return out.index_add_(0, seg, src)
def _pad(x, pw):
    flat = tuple(v for pair in reversed(pw) for v in pair)
    return torch.nn.functional.pad(x, flat)

kernel_name = 'parallel_sum__ssm_conv_h3__dense_activation_silu__prompt'

def setup_inputs():

    _w = (lambda a: (lambda t: t.to(torch.bfloat16) if t.is_floating_point() else t)(torch.as_tensor(a)))
    def _A_setup():
        B, S, D = 1, 2048, 640
        ks = 4
        return {
            "q": _w((lambda *s: torch.randn(*s, dtype=torch.bfloat16) * 0.05)(B, S, D)),
            "k": _w((lambda *s: torch.randn(*s, dtype=torch.bfloat16) * 0.2)(B, S, D)),
            "v": _w((lambda *s: torch.randn(*s, dtype=torch.bfloat16) * 0.2)(B, S, D)),
            "shift_k": _w((lambda *s: torch.randn(*s, dtype=torch.bfloat16) * 0.2)(D, ks) * 0.5),
            "ssm_k": _w((lambda *s: torch.randn(*s, dtype=torch.bfloat16) * 0.4)(D, S) * (1.0 / S ** 0.5)),
            "ssm_D": _w((lambda *s: torch.randn(*s, dtype=torch.bfloat16) * 0.2)(D)),
        }
    _A_in = _A_setup()

    def _B_setup():
        B, S, D, F = 1, 2048, 640, 1728
        return {
            "x": _w((lambda *s: torch.randn(*s, dtype=torch.bfloat16) * 0.05)(B, S, D)),
            "w1": _w((lambda *s: torch.randn(*s, dtype=torch.bfloat16) * 0.8)(D, F) * (D ** -0.5)),
            "w2": _w((lambda *s: torch.randn(*s, dtype=torch.bfloat16) * 0.1)(F, D) * (F ** -0.5)),
        }
    _B_in = _B_setup()

    return {
        "A_q": _A_in["q"],
        "A_k": _A_in["k"],
        "A_v": _A_in["v"],
        "A_shift_k": _A_in["shift_k"],
        "A_ssm_k": _A_in["ssm_k"],
        "A_ssm_D": _A_in["ssm_D"],
        "B_x": _B_in["x"],
        "B_w1": _B_in["w1"],
        "B_w2": _B_in["w2"],
    }

def reference(A_q, A_k, A_v, A_shift_k, A_ssm_k, A_ssm_D, B_x, B_w1, B_w2):
    def _A_ref(q, k, v, shift_k, ssm_k, ssm_D):
        B, S, D = q.shape
        ks = shift_k.shape[-1]
        k_pad = _pad(k, ((0, 0), (ks - 1, 0), (0, 0)))
        k_shift = torch.zeros_like(k)
        for t in range(ks):
            k_shift = k_shift + k_pad[:, t:t + S, :] * shift_k[:, ks - 1 - t][None, None, :]
        kv = k_shift * v
        L = 2 * S
        kv_pad = _pad(kv, ((0, 0), (0, S), (0, 0)))
        kf_pad = _pad(ssm_k, ((0, 0), (0, S)))
        kv_f = (lambda x, axes=(-2,-1): torch.fft.rfft2(x.float(), dim=axes))(kv_pad[:, None, :, :], axes=(1, 2))
        kf_f = (lambda x, axes=(-2,-1): torch.fft.rfft2(x.float(), dim=axes))(kf_pad[:, None, :], axes=(1, 2))
        kf_f = (lambda x, *d: x.permute(*d))(kf_f, 1, 2, 0)
        y_f = kv_f * kf_f[None, :, :, :]
        y = (lambda x, s, axes=(-2,-1): torch.fft.irfft2(x, s=s, dim=axes).to(torch.bfloat16))(y_f, (1, L), axes=(1, 2))[:, 0, :S, :]
        y = y + kv * ssm_D[None, None, :]
        return q * y

    def _B_ref(x, w1, w2):
        h = torch.einsum("bsd,df->bsf", x, w1)
        h = _silu(h)
        out = torch.einsum("bsf,fd->bsd", h, w2)
        return out

    x = A_q
    xn = _layernorm(x, axis=-1)
    return x + _A_ref(xn, A_k, A_v, A_shift_k, A_ssm_k, A_ssm_D) + _B_ref(xn, B_w1, B_w2)
```

```asm
; @launch grid=(256,1,1) block=(256,1,1) lds=163328
.amdgcn_target "amdgcn-amd-amdhsa--gfx950"
.text
.globl parallel_sum__ssm_conv_h3__dense_activation_silu__prompt_kernel
.p2align 12
.p2align 8
.type parallel_sum__ssm_conv_h3__dense_activation_silu__prompt_kernel,@function
parallel_sum__ssm_conv_h3__dense_activation_silu__prompt_kernel:
    s_cmp_ge_u32 s2, 256
    s_cbranch_scc1 L_end
    s_load_dwordx16 s[4:19], s[0:1], 0
    s_load_dwordx8 s[20:27], s[0:1], 64
    v_lshrrev_b32 v1, 6, v0
    v_and_b32 v0, 63, v0
    v_readfirstlane_b32 s64, v1
    s_and_b32 s66, s2, 7
    s_lshr_b32 s67, s2, 3
    s_getpc_b64 s[70:71]
L_pc:
    s_lshl_b32 s72, s67, 2
    s_add_u32 s72, s72, s64
    s_mul_i32 s72, s72, (L_end-L_pc+16383)/16384*128
    v_lshl_add_u32 v2, v0, 7, s72
    v_min_u32 v2, L_end-L_pc, v2
    s_mov_b32 exec_lo, (1<<((L_end-L_pc+16383)/16384))-1
    s_mov_b32 exec_hi, 0
    global_load_dword a255, v2, s[70:71]
    s_mov_b64 exec, -1
    s_lshr_b32 s68, s66, 1
    s_and_b32 s69, s66, 1
    v_and_b32 v31, 31, v0
    v_lshlrev_b32 v31, 2, v31
    s_mov_b32 s30, 2621440
    s_mov_b32 s31, 0x20000
    s_mov_b32 s34, 2621440
    s_mov_b32 s35, 0x20000
    s_mov_b32 s38, 2621440
    s_mov_b32 s39, 0x20000
    s_mov_b32 s42, 2211840
    s_mov_b32 s43, 0x20000
    s_mov_b32 s46, 2211840
    s_mov_b32 s47, 0x20000
    s_mov_b32 s50, 2621440
    s_mov_b32 s51, 0x20000
    s_mov_b32 s54, 2621440
    s_mov_b32 s55, 0x20000
    s_mov_b32 s58, 15171584
    s_mov_b32 s59, 0x20000
    s_mov_b32 s62, 5120
    s_mov_b32 s63, 0x20000
    s_cmp_ge_u32 s2, 144
    s_cbranch_scc0 L_roleG
L_roleF:
    s_sub_u32 s3, s2, 144
    s_mul_i32 s79, s3, 3
    s_min_u32 s79, s79, 317
    s_sub_u32 s85, s67, 18
    s_mul_i32 s87, s69, 14
    s_add_u32 s85, s85, s87
    s_mul_i32 s84, s68, 552960
    s_mul_i32 s87, s64, 138240
    s_add_u32 s84, s84, s87
    s_mul_i32 s87, s85, 128
    s_add_u32 s84, s84, s87
    s_cmp_ge_u32 s85, 27
    s_cselect_b32 s84, 0x80000000, s84
    s_and_b32 s86, s64, 1
    s_lshl_b32 s86, s86, 2
    v_lshrrev_b32 v33, 3, v0
    v_mul_u32_u24 v34, 3456, v33
    v_and_or_b32 v33, v33, 2, s86
    v_xor_b32 v33, v33, v0
    v_and_b32 v33, 7, v33
    v_lshlrev_b32 v33, 4, v33
    v_add3_u32 v11, v33, v34, s84
    v_xor_b32 v12, 64, v11
    s_mul_i32 s91, s68, 7168
    s_mul_i32 s87, s85, 256
    s_add_u32 s91, s91, s87
    s_mul_i32 s87, s64, 64
    s_add_u32 s91, s91, s87
    s_add_u32 s91, s91, 163840
    s_mul_i32 s86, s64, 20480
    v_lshrrev_b32 v33, 5, v0
    v_mul_u32_u24 v33, 10240, v33
    v_add3_u32 v238, v33, v31, s86
    s_cmp_eq_u32 s3, 106
    s_cselect_b32 s84, -1, 0
    s_mul_i32 s85, s3, 3
    s_add_u32 s85, s85, s84
    s_mul_i32 s84, s85, 205
    s_lshr_b32 s84, s84, 11
    s_mul_i32 s87, s84, -10
    s_add_u32 s85, s85, s87
    s_mul_i32 s86, s84, 81920
    s_mul_i32 s87, s85, 128
    s_add_u32 s86, s86, s87
    v_add_u32 v233, s86, v238
    s_lshl_b32 s86, s85, 9
    v_lshl_add_u32 v234, v31, 2, s86
    v_subrev_u32 v232, 3840, v233
    v_min_u32 v232, 0x80000000, v232
    s_mul_i32 s96, s85, 270336
    s_mul_i32 s87, s64, 67584
    s_add_u32 s96, s96, s87
    s_mul_i32 s87, s84, -128
    s_add_u32 s96, s96, s87
    s_add_u32 s96, s96, 216960
    s_mul_i32 s89, s79, 8192
    s_mul_i32 s87, s64, 2048
    s_add_u32 s89, s89, s87
    s_and_b32 s85, s64, 1
    s_cselect_b64 s[80:81], -1, 0
    s_waitcnt lgkmcnt(0)
    s_mov_b64 s[40:41], s[18:19]
    s_mov_b64 s[28:29], s[4:5]
    s_mov_b64 s[32:33], s[6:7]
    s_mov_b64 s[36:37], s[8:9]
    s_mov_b64 s[60:61], s[10:11]
    s_mov_b64 s[56:57], s[26:27]
    s_mov_b64 s[48:49], s[12:13]
    s_load_dword s65, s[56:57], 0
    s_lshl_b32 s4, s79, 2
    s_andn2_b32 s5, s89, 2048
    s_load_dword s17, s[14:15], s4 offset:0
    s_load_dwordx2 s[72:73], s[48:49], s5 offset:2040
    s_load_dword s18, s[14:15], s4 offset:4
    s_load_dwordx2 s[74:75], s[48:49], s5 offset:10232
    s_load_dword s19, s[14:15], s4 offset:8
    s_load_dwordx2 s[82:83], s[48:49], s5 offset:18424
    s_mul_i32 s1, s64, 5120
    s_add_u32 m0, s1, 91136
    s_mov_b32 s0, 0
    buffer_load_dwordx4 v11, s[40:43], s0 offen lds
    s_add_u32 m0, s1, 92160
    s_mov_b32 s0, 27648
    buffer_load_dwordx4 v12, s[40:43], s0 offen lds
    s_add_u32 m0, s1, 93184
    s_mov_b32 s0, 55296
    buffer_load_dwordx4 v11, s[40:43], s0 offen lds
    s_add_u32 m0, s1, 94208
    s_mov_b32 s0, 82944
    buffer_load_dwordx4 v12, s[40:43], s0 offen lds
    s_add_u32 m0, s1, 95232
    s_mov_b32 s0, 110592
    buffer_load_dwordx4 v11, s[40:43], s0 offen lds
    s_mov_b32 s0, 5120
    buffer_load_dwordx4 v[64:67], v234, s[60:63], 0 offen
    buffer_load_dword v44, v232, s[32:35], 0 offen offset:0
    buffer_load_dword v45, v232, s[32:35], 0 offen offset:1280
    buffer_load_dword v46, v232, s[32:35], 0 offen offset:2560
    buffer_load_dword v47, v233, s[32:35], 0 offen offset:0
    buffer_load_dword v48, v233, s[32:35], 0 offen offset:1280
    buffer_load_dword v49, v233, s[32:35], 0 offen offset:2560
    buffer_load_dword v50, v233, s[32:35], 0 offen offset:3840
    buffer_load_dword v51, v233, s[32:35], s0 offen offset:0
    buffer_load_dword v52, v233, s[32:35], s0 offen offset:1280
    buffer_load_dword v53, v233, s[32:35], s0 offen offset:2560
    buffer_load_dword v54, v233, s[32:35], s0 offen offset:3840
    buffer_load_dword v55, v233, s[36:39], 0 offen offset:0 nt
    buffer_load_dword v56, v233, s[36:39], 0 offen offset:1280 nt
    buffer_load_dword v57, v233, s[36:39], 0 offen offset:2560 nt
    buffer_load_dword v58, v233, s[36:39], 0 offen offset:3840 nt
    buffer_load_dword v59, v233, s[36:39], s0 offen offset:0 nt
    buffer_load_dword v60, v233, s[36:39], s0 offen offset:1280 nt
    buffer_load_dword v61, v233, s[36:39], s0 offen offset:2560 nt
    buffer_load_dword v62, v233, s[36:39], s0 offen offset:3840 nt
    s_branch L_F1
L_wret:
    s_cmp_eq_u32 s101, 1
    s_cbranch_scc1 L_wb_F
    s_branch L_wb_G
L_roleG:
    s_mul_i32 s84, s66, 327680
    s_mul_i32 s87, s67, 1280
    s_add_u32 s84, s84, s87
    s_mul_i32 s87, s64, 40960
    s_add_u32 s84, s84, s87
    s_cmp_ge_u32 s67, 16
    s_cselect_b32 s84, 0x80000000, s84
    v_lshrrev_b32 v33, 5, v0
    v_mul_u32_u24 v253, 20480, v33
    v_add3_u32 v253, v253, v31, s84
    s_mul_i32 s84, s64, 8
    s_add_u32 s84, s84, 161280
    v_lshl_add_u32 v254, v33, 2, s84
    s_and_b32 s84, s67, 3
    s_lshr_b32 s85, s67, 2
    s_cmp_ge_u32 s67, 16
    s_cselect_b32 s86, s69, 0
    s_mul_i32 s70, s68, 4
    s_add_u32 s70, s70, s84
    s_mul_i32 s87, s86, 2
    s_add_u32 s70, s70, s87
    s_mul_i32 s71, s69, 5
    s_add_u32 s71, s71, s85
    s_mul_i32 s87, s86, -5
    s_add_u32 s71, s71, s87
    s_mul_i32 s84, s70, 163840
    s_mul_i32 s87, s64, 40960
    s_add_u32 s84, s84, s87
    v_lshrrev_b32 v33, 3, v0
    v_mul_u32_u24 v33, 1280, v33
    v_lshrrev_b32 v34, 4, v0
    v_xor_b32 v35, v34, v0
    v_and_b32 v35, 7, v35
    v_lshlrev_b32 v35, 4, v35
    v_add3_u32 v1, v33, v35, s84
    v_xor_b32 v2, 64, v1
    v_add_u32 v2, 9216, v2
    v_add_u32 v3, 18432, v1
    v_add_u32 v4, 18432, v2
    s_mul_i32 s84, s64, 55296
    s_mul_i32 s87, s71, 384
    s_add_u32 s84, s84, s87
    v_lshrrev_b32 v33, 3, v0
    v_mul_u32_u24 v34, 3456, v33
    v_and_b32 v33, 2, v33
    v_xor_b32 v33, v33, v0
    v_and_b32 v33, 7, v33
    v_lshlrev_b32 v33, 4, v33
    v_add3_u32 v5, v33, v34, s84
    v_xor_b32 v6, 64, v5
    v_add_u32 v6, 26624, v6
    s_lshl_b32 s76, s64, 11
    s_mul_i32 s75, s64, 4096
    s_add_u32 s75, s75, 73728
    s_waitcnt lgkmcnt(0)
    s_mov_b64 s[28:29], s[4:5]
    s_mov_b64 s[40:41], s[18:19]
    s_mov_b64 s[56:57], s[26:27]
    s_load_dword s65, s[56:57], 0
    buffer_load_dword v160, v253, s[28:31], 0 offen offset:0
    buffer_load_dword v161, v253, s[28:31], 0 offen offset:128
    buffer_load_dword v162, v253, s[28:31], 0 offen offset:256
    buffer_load_dword v163, v253, s[28:31], 0 offen offset:384
    buffer_load_dword v164, v253, s[28:31], 0 offen offset:512
    buffer_load_dword v165, v253, s[28:31], 0 offen offset:640
    buffer_load_dword v166, v253, s[28:31], 0 offen offset:768
    buffer_load_dword v167, v253, s[28:31], 0 offen offset:896
    buffer_load_dword v168, v253, s[28:31], 0 offen offset:1024
    buffer_load_dword v169, v253, s[28:31], 0 offen offset:1152
    s_mov_b32 s0, 163840
    buffer_load_dword v100, v253, s[28:31], s0 offen offset:0
    buffer_load_dword v101, v253, s[28:31], s0 offen offset:128
    buffer_load_dword v102, v253, s[28:31], s0 offen offset:256
    buffer_load_dword v103, v253, s[28:31], s0 offen offset:384
    buffer_load_dword v104, v253, s[28:31], s0 offen offset:512
    buffer_load_dword v105, v253, s[28:31], s0 offen offset:640
    buffer_load_dword v106, v253, s[28:31], s0 offen offset:768
    buffer_load_dword v107, v253, s[28:31], s0 offen offset:896
    buffer_load_dword v108, v253, s[28:31], s0 offen offset:1024
    buffer_load_dword v109, v253, s[28:31], s0 offen offset:1152
    s_add_u32 m0, s76, 0
    s_mov_b32 s74, 0
    buffer_load_dwordx4 v5, s[40:43], s74 offen offset:0 lds
    buffer_load_dwordx4 v6, s[40:43], s74 offen offset:1024 lds
    s_add_u32 m0, s76, 8192
    s_mov_b32 s74, 128
    buffer_load_dwordx4 v5, s[40:43], s74 offen offset:0 lds
    buffer_load_dwordx4 v6, s[40:43], s74 offen offset:1024 lds
    s_add_u32 m0, s76, 16384
    s_mov_b32 s74, 256
    buffer_load_dwordx4 v5, s[40:43], s74 offen offset:0 lds
    buffer_load_dwordx4 v6, s[40:43], s74 offen offset:1024 lds
    s_add_u32 m0, s75, 0
    s_movk_i32 s73, 0
    buffer_load_dwordx4 v1, s[28:31], s73 offen offset:0 lds
    buffer_load_dwordx4 v2, s[28:31], s73 offen offset:1024 lds
L_G1:
    s_mov_b64 s[52:53], s[22:23]
    s_mov_b64 s[32:33], s[6:7]
    s_mov_b64 s[36:37], s[8:9]
    s_mov_b64 s[60:61], s[10:11]
    s_mov_b64 s[48:49], s[12:13]
    s_mov_b64 s[44:45], s[20:21]
    s_mov_b32 s8, 0x40000
    v_lshlrev_b32 v14, 4, v0
    v_lshlrev_b32 v16, 3, v0
    v_lshrrev_b32 v34, 4, v0
    v_or_b32 v35, s64, v34
    v_min_u32 v35, 1, v35
    v_lshl_or_b32 v17, v35, 31, v31
    v_and_b32 v33, 15, v0
    v_lshlrev_b32 v28, 6, v33
    v_lshrrev_b32 v35, 3, v0
    v_mul_u32_u24 v35, 4096, v35
    v_add_u32 v27, v35, v14
    s_lshr_b32 s4, s64, 1
    s_and_b32 s5, s64, 1
    v_lshrrev_b32 v34, 4, v0
    v_bfe_u32 v33, v0, 2, 2
    v_lshl_add_u32 v33, v34, 3, v33
    v_and_b32 v35, 24, v16
    v_lshl_add_u32 v33, v33, 7, v35
    v_bfe_u32 v35, v0, 3, 2
    v_lshl_add_u32 v33, v35, 5, v33
    s_mul_i32 s6, s4, 8256
    v_xor_b32 v7, s6, v33
    s_mul_i32 s6, s4, 8256
    s_add_u32 s6, s6, 32
    v_xor_b32 v8, s6, v33
    s_mul_i32 s6, s4, 16320
    s_add_u32 s6, s6, 64
    v_xor_b32 v9, s6, v33
    s_mul_i32 s6, s4, 16320
    s_add_u32 s6, s6, 96
    v_xor_b32 v10, s6, v33
    s_mul_i32 s6, s4, 8256
    s_add_u32 s6, s6, 8192
    v_xor_b32 v11, s6, v33
    s_mul_i32 s6, s4, 8256
    s_add_u32 s6, s6, 8224
    v_xor_b32 v12, s6, v33
    v_bfe_u32 v33, v0, 1, 3
    v_xor_b32 v33, v33, v34
    v_lshlrev_b32 v33, 4, v33
    v_lshl_add_u32 v33, v28, 1, v33
    s_mul_i32 s6, s5, 8192
    s_add_u32 s6, s6, 73728
    v_xor_b32 v13, s6, v33
    v_xor_b32 v134, 64, v13
    s_mov_b32 s82, 0xbfb8aa3b
    s_mov_b32 s83, 0xbfb8aa3b
    s_mul_i32 s91, s70, 1024
    s_mul_i32 s7, s64, 256
    s_add_u32 s91, s91, s7
    s_add_u32 s91, s91, 16384
    s_mul_i32 s22, s70, 458752
    s_mul_i32 s7, s5, 229376
    s_add_u32 s22, s22, s7
    s_mul_i32 s7, s71, 6144
    s_add_u32 s22, s22, s7
    s_mul_i32 s7, s4, 3072
    s_add_u32 s22, s22, s7
    s_add_u32 s22, s22, 7831552
    s_mul_i32 s11, s70, 1024
    s_mul_i32 s7, s71, 64
    s_add_u32 s11, s11, s7
    s_add_u32 s11, s11, 32768
    s_and_b32 s78, s67, 3
    s_mul_i32 s7, s69, 4
    s_add_u32 s78, s78, s7
    s_mul_i32 s23, s78, 276480
    s_mul_i32 s7, s64, 71680
    s_add_u32 s23, s23, s7
    s_add_u32 s23, s23, 5619712
L_wa_G:
    s_mov_b32 s101, 0
    s_mov_b64 exec, 0
    s_cmp_eq_u32 s64, 0
    s_cbranch_scc1 L_st0
    s_cmp_eq_u32 s64, 1
    s_cbranch_scc1 L_st1
    s_cmp_eq_u32 s64, 2
    s_cbranch_scc1 L_st2
    s_branch L_st5
L_wb_G:
    s_mov_b64 exec, -1
    s_waitcnt lgkmcnt(0)
    s_mul_i32 s65, s65, 0x9e3779b1
    s_add_u32 s65, s65, 0x7f4a7c15
    v_mov_b32 v19, s65
    buffer_load_dwordx4 v3, s[28:31], s73 offen offset:2048 lds
    buffer_load_dwordx4 v4, s[28:31], s73 offen offset:3072 lds
    s_waitcnt vmcnt(10)
    v_lshlrev_b32 v170, 16, v160
    s_add_u32 m0, s76, 24576
    s_mov_b32 s74, 221184
    buffer_load_dwordx4 v5, s[40:43], s74 offen offset:0 lds
    v_lshlrev_b32 v110, 16, v100
    v_and_b32 v171, 0xffff0000, v160
    v_and_b32 v111, 0xffff0000, v100
    v_lshlrev_b32 v172, 16, v161
    v_lshlrev_b32 v112, 16, v101
    v_and_b32 v173, 0xffff0000, v161
    v_and_b32 v113, 0xffff0000, v101
    v_lshlrev_b32 v174, 16, v162
    v_lshlrev_b32 v114, 16, v102
    v_and_b32 v175, 0xffff0000, v162
    v_and_b32 v115, 0xffff0000, v102
    v_lshlrev_b32 v176, 16, v163
    v_lshlrev_b32 v116, 16, v103
    v_and_b32 v177, 0xffff0000, v163
    v_and_b32 v117, 0xffff0000, v103
    v_lshlrev_b32 v178, 16, v164
    v_lshlrev_b32 v118, 16, v104
    v_and_b32 v179, 0xffff0000, v164
    v_and_b32 v119, 0xffff0000, v104
    v_lshlrev_b32 v180, 16, v165
    v_lshlrev_b32 v120, 16, v105
    v_and_b32 v181, 0xffff0000, v165
    v_and_b32 v121, 0xffff0000, v105
    v_lshlrev_b32 v182, 16, v166
    buffer_load_dwordx4 v6, s[40:43], s74 offen offset:1024 lds
    v_lshlrev_b32 v122, 16, v106
    v_and_b32 v183, 0xffff0000, v166
    v_and_b32 v123, 0xffff0000, v106
    v_lshlrev_b32 v184, 16, v167
    v_lshlrev_b32 v124, 16, v107
    v_and_b32 v185, 0xffff0000, v167
    v_and_b32 v125, 0xffff0000, v107
    v_lshlrev_b32 v186, 16, v168
    v_lshlrev_b32 v126, 16, v108
    v_and_b32 v187, 0xffff0000, v168
    v_and_b32 v127, 0xffff0000, v108
    v_lshlrev_b32 v188, 16, v169
    v_lshlrev_b32 v128, 16, v109
    v_and_b32 v189, 0xffff0000, v169
    v_and_b32 v129, 0xffff0000, v109
    v_pk_add_f32 v[190:191], v[170:171], v[172:173]
    v_pk_add_f32 v[130:131], v[110:111], v[112:113]
    v_pk_add_f32 v[190:191], v[190:191], v[174:175]
    v_pk_add_f32 v[130:131], v[130:131], v[114:115]
    v_pk_add_f32 v[190:191], v[190:191], v[176:177]
    v_pk_add_f32 v[130:131], v[130:131], v[116:117]
    v_pk_add_f32 v[190:191], v[190:191], v[178:179]
    v_pk_add_f32 v[130:131], v[130:131], v[118:119]
    v_pk_add_f32 v[190:191], v[190:191], v[180:181]
    s_add_u32 m0, s76, 32768
    s_mov_b32 s74, 221312
    buffer_load_dwordx4 v5, s[40:43], s74 offen offset:0 lds
    v_pk_add_f32 v[130:131], v[130:131], v[120:121]
    v_pk_add_f32 v[190:191], v[190:191], v[182:183]
    v_pk_add_f32 v[130:131], v[130:131], v[122:123]
    v_pk_add_f32 v[190:191], v[190:191], v[184:185]
    v_pk_add_f32 v[130:131], v[130:131], v[124:125]
    v_pk_add_f32 v[190:191], v[190:191], v[186:187]
    v_pk_add_f32 v[130:131], v[130:131], v[126:127]
    v_pk_add_f32 v[190:191], v[190:191], v[188:189]
    v_pk_add_f32 v[130:131], v[130:131], v[128:129]
    v_add_f32 v190, v190, v191
    v_add_f32 v130, v130, v131
    s_nop 0
    v_add_f32_dpp v190, v190, v190 row_ror:8 row_mask:0xf bank_mask:0xf
    v_add_f32_dpp v130, v130, v130 row_ror:8 row_mask:0xf bank_mask:0xf
    s_nop 0
    v_add_f32_dpp v190, v190, v190 row_ror:4 row_mask:0xf bank_mask:0xf
    v_add_f32_dpp v130, v130, v130 row_ror:4 row_mask:0xf bank_mask:0xf
    s_nop 0
    v_add_f32_dpp v190, v190, v190 row_ror:2 row_mask:0xf bank_mask:0xf
    v_add_f32_dpp v130, v130, v130 row_ror:2 row_mask:0xf bank_mask:0xf
    s_nop 0
    v_add_f32_dpp v190, v190, v190 row_ror:1 row_mask:0xf bank_mask:0xf
    v_add_f32_dpp v130, v130, v130 row_ror:1 row_mask:0xf bank_mask:0xf
    v_mov_b32 v191, v190
    v_mov_b32 v131, v130
    s_nop 0
    v_permlane16_swap_b32 v190, v191
    v_permlane16_swap_b32 v130, v131
    v_add_f32 v190, v190, v191
    v_add_f32 v130, v130, v131
    buffer_load_dwordx4 v6, s[40:43], s74 offen offset:1024 lds
    v_mul_f32 v190, 0x3acccccd, v190
    v_mul_f32 v130, 0x3acccccd, v130
    v_pk_add_f32 v[170:171], v[170:171], v[190:191] op_sel_hi:[1,0] neg_lo:[0,1] neg_hi:[0,1]
    v_pk_add_f32 v[110:111], v[110:111], v[130:131] op_sel_hi:[1,0] neg_lo:[0,1] neg_hi:[0,1]
    v_pk_add_f32 v[172:173], v[172:173], v[190:191] op_sel_hi:[1,0] neg_lo:[0,1] neg_hi:[0,1]
    v_pk_add_f32 v[112:113], v[112:113], v[130:131] op_sel_hi:[1,0] neg_lo:[0,1] neg_hi:[0,1]
    v_pk_add_f32 v[174:175], v[174:175], v[190:191] op_sel_hi:[1,0] neg_lo:[0,1] neg_hi:[0,1]
    v_pk_add_f32 v[114:115], v[114:115], v[130:131] op_sel_hi:[1,0] neg_lo:[0,1] neg_hi:[0,1]
    v_pk_add_f32 v[176:177], v[176:177], v[190:191] op_sel_hi:[1,0] neg_lo:[0,1] neg_hi:[0,1]
    v_pk_add_f32 v[116:117], v[116:117], v[130:131] op_sel_hi:[1,0] neg_lo:[0,1] neg_hi:[0,1]
    v_pk_add_f32 v[178:179], v[178:179], v[190:191] op_sel_hi:[1,0] neg_lo:[0,1] neg_hi:[0,1]
    v_pk_add_f32 v[118:119], v[118:119], v[130:131] op_sel_hi:[1,0] neg_lo:[0,1] neg_hi:[0,1]
    v_pk_add_f32 v[180:181], v[180:181], v[190:191] op_sel_hi:[1,0] neg_lo:[0,1] neg_hi:[0,1]
    v_pk_add_f32 v[120:121], v[120:121], v[130:131] op_sel_hi:[1,0] neg_lo:[0,1] neg_hi:[0,1]
    v_pk_add_f32 v[182:183], v[182:183], v[190:191] op_sel_hi:[1,0] neg_lo:[0,1] neg_hi:[0,1]
    v_pk_add_f32 v[122:123], v[122:123], v[130:131] op_sel_hi:[1,0] neg_lo:[0,1] neg_hi:[0,1]
    v_pk_add_f32 v[184:185], v[184:185], v[190:191] op_sel_hi:[1,0] neg_lo:[0,1] neg_hi:[0,1]
    v_pk_add_f32 v[124:125], v[124:125], v[130:131] op_sel_hi:[1,0] neg_lo:[0,1] neg_hi:[0,1]
    v_pk_add_f32 v[186:187], v[186:187], v[190:191] op_sel_hi:[1,0] neg_lo:[0,1] neg_hi:[0,1]
    v_pk_add_f32 v[126:127], v[126:127], v[130:131] op_sel_hi:[1,0] neg_lo:[0,1] neg_hi:[0,1]
    v_pk_add_f32 v[188:189], v[188:189], v[190:191] op_sel_hi:[1,0] neg_lo:[0,1] neg_hi:[0,1]
    v_pk_add_f32 v[128:129], v[128:129], v[130:131] op_sel_hi:[1,0] neg_lo:[0,1] neg_hi:[0,1]
    v_pk_mul_f32 v[192:193], v[170:171], v[170:171]
    v_pk_mul_f32 v[132:133], v[110:111], v[110:111]
    s_add_u32 m0, s76, 40960
    s_mov_b32 s74, 221440
    buffer_load_dwordx4 v5, s[40:43], s74 offen offset:0 lds
    v_pk_fma_f32 v[192:193], v[172:173], v[172:173], v[192:193]
    v_pk_fma_f32 v[132:133], v[112:113], v[112:113], v[132:133]
    v_pk_fma_f32 v[192:193], v[174:175], v[174:175], v[192:193]
    v_pk_fma_f32 v[132:133], v[114:115], v[114:115], v[132:133]
    v_pk_fma_f32 v[192:193], v[176:177], v[176:177], v[192:193]
    v_pk_fma_f32 v[132:133], v[116:117], v[116:117], v[132:133]
    v_pk_fma_f32 v[192:193], v[178:179], v[178:179], v[192:193]
    v_pk_fma_f32 v[132:133], v[118:119], v[118:119], v[132:133]
    v_pk_fma_f32 v[192:193], v[180:181], v[180:181], v[192:193]
    v_pk_fma_f32 v[132:133], v[120:121], v[120:121], v[132:133]
    v_pk_fma_f32 v[192:193], v[182:183], v[182:183], v[192:193]
    v_pk_fma_f32 v[132:133], v[122:123], v[122:123], v[132:133]
    v_pk_fma_f32 v[192:193], v[184:185], v[184:185], v[192:193]
    v_pk_fma_f32 v[132:133], v[124:125], v[124:125], v[132:133]
    v_pk_fma_f32 v[192:193], v[186:187], v[186:187], v[192:193]
    v_pk_fma_f32 v[132:133], v[126:127], v[126:127], v[132:133]
    v_pk_fma_f32 v[192:193], v[188:189], v[188:189], v[192:193]
    v_pk_fma_f32 v[132:133], v[128:129], v[128:129], v[132:133]
    v_add_f32 v192, v192, v193
    v_add_f32 v132, v132, v133
    s_nop 0
    v_add_f32_dpp v192, v192, v192 row_ror:8 row_mask:0xf bank_mask:0xf
    v_add_f32_dpp v132, v132, v132 row_ror:8 row_mask:0xf bank_mask:0xf
    s_nop 0
    v_add_f32_dpp v192, v192, v192 row_ror:4 row_mask:0xf bank_mask:0xf
    v_add_f32_dpp v132, v132, v132 row_ror:4 row_mask:0xf bank_mask:0xf
    buffer_load_dwordx4 v6, s[40:43], s74 offen offset:1024 lds
    v_add_f32_dpp v192, v192, v192 row_ror:2 row_mask:0xf bank_mask:0xf
    v_add_f32_dpp v132, v132, v132 row_ror:2 row_mask:0xf bank_mask:0xf
    s_nop 0
    v_add_f32_dpp v192, v192, v192 row_ror:1 row_mask:0xf bank_mask:0xf
    v_add_f32_dpp v132, v132, v132 row_ror:1 row_mask:0xf bank_mask:0xf
    v_mov_b32 v193, v192
    v_mov_b32 v133, v132
    s_nop 0
    v_permlane16_swap_b32 v192, v193
    v_permlane16_swap_b32 v132, v133
    v_add_f32 v192, v192, v193
    v_add_f32 v132, v132, v133
    v_mul_f32 v192, 0x3acccccd, v192
    v_mul_f32 v132, 0x3acccccd, v132
    v_cvt_pk_bf16_f32 v192, 0, v192
    v_cvt_pk_bf16_f32 v132, 0, v132
    v_add_f32 v192, 0x3727c5ac, v192
    v_add_f32 v132, 0x3727c5ac, v132
    v_cvt_pk_bf16_f32 v192, 0, v192
    v_cvt_pk_bf16_f32 v132, 0, v132
    v_sqrt_f32 v192, v192
    v_sqrt_f32 v132, v132
    v_cvt_pk_bf16_f32 v190, v190, v192
    v_cvt_pk_bf16_f32 v130, v130, v132
    ds_write_b32 v254, v190 offset:0
    ds_write_b32 v254, v130 offset:32
L_st0:
    s_cbranch_execz L_st3
    s_add_u32 m0, s75, 16384
    s_movk_i32 s73, 128
    buffer_load_dwordx4 v1, s[28:31], s73 offen offset:0 lds
    buffer_load_dwordx4 v2, s[28:31], s73 offen offset:1024 lds
    buffer_load_dwordx4 v3, s[28:31], s73 offen offset:2048 lds
    buffer_load_dwordx4 v4, s[28:31], s73 offen offset:3072 lds
    v_bfe_u32 v34, v0, 4, 1
    v_and_b32 v252, 28, v31
    v_lshl_add_u32 v252, v34, 5, v252
    v_add_u32 v252, 161280, v252
    v_mul_u32_u24 v34, 960, v34
    v_add_u32 v34, v34, v31
    v_lshrrev_b32 v35, 5, v0
    v_or_b32 v35, s64, v35
    v_min_u32 v35, 1, v35
    v_lshl_or_b32 v34, v35, 31, v34
    s_lshr_b32 s4, s67, 4
    s_mul_i32 s4, s4, 179200
    s_mul_i32 s7, s66, 2048
    s_add_u32 s4, s4, s7
    s_mul_i32 s7, s67, 64
    s_add_u32 s4, s4, s7
    s_add_u32 s4, s4, 16384
    s_mov_b32 vcc_lo, 0x00ff00ff
    s_waitcnt vmcnt(10) lgkmcnt(0)
    s_barrier
    ds_read_b32 v252, v252
    ds_read_b128 v[160:163], v13 offset:0
    ds_read_b64_tr_b16 v[136:137], v7 offset:0
    ds_read_b64_tr_b16 v[138:139], v7 offset:512
    ds_read_b64_tr_b16 v[140:141], v8 offset:0
    ds_read_b64_tr_b16 v[142:143], v8 offset:512
    ds_read_b64_tr_b16 v[144:145], v9 offset:0
    ds_read_b64_tr_b16 v[146:147], v9 offset:512
    ds_read_b64_tr_b16 v[148:149], v10 offset:0
    ds_read_b64_tr_b16 v[150:151], v10 offset:512
    ds_read_b64_tr_b16 v[152:153], v11 offset:0
    ds_read_b64_tr_b16 v[154:155], v11 offset:512
    ds_read_b64_tr_b16 v[156:157], v12 offset:0
    ds_read_b64_tr_b16 v[158:159], v12 offset:512
    ds_read_b128 v[164:167], v13 offset:2048
    ds_read_b128 v[168:171], v13 offset:4096
    ds_read_b128 v[172:175], v13 offset:6144
    s_waitcnt lgkmcnt(13)
    v_mfma_f32_16x16x32_bf16 v[36:39], v[136:139], v[160:163], 0
    v_cndmask_b32 v252, v19, v252, vcc
    s_waitcnt lgkmcnt(11)
    v_mfma_f32_16x16x32_bf16 v[40:43], v[140:143], v[160:163], 0
    buffer_store_dword v252, v34, s[56:59], s4 offen sc1
    s_waitcnt lgkmcnt(9)
    v_mfma_f32_16x16x32_bf16 v[44:47], v[144:147], v[160:163], 0
    s_add_u32 m0, s76, 49152
    s_waitcnt lgkmcnt(7)
    v_mfma_f32_16x16x32_bf16 v[48:51], v[148:151], v[160:163], 0
    ds_read_b128 v[200:203], v134 offset:0
    s_mov_b32 s74, 442368
    s_waitcnt lgkmcnt(6)
    v_mfma_f32_16x16x32_bf16 v[52:55], v[152:155], v[160:163], 0
    ds_read_b64_tr_b16 v[176:177], v7 offset:4096
    buffer_load_dwordx4 v5, s[40:43], s74 offen offset:0 lds
    s_waitcnt lgkmcnt(5)
    v_mfma_f32_16x16x32_bf16 v[56:59], v[156:159], v[160:163], 0
    ds_read_b64_tr_b16 v[178:179], v7 offset:4608
    s_waitcnt lgkmcnt(5)
    v_mfma_f32_16x16x32_bf16 v[60:63], v[136:139], v[164:167], 0
    ds_read_b64_tr_b16 v[180:181], v8 offset:4096
    v_mfma_f32_16x16x32_bf16 v[64:67], v[140:143], v[164:167], 0
    ds_read_b64_tr_b16 v[182:183], v8 offset:4608
    v_mfma_f32_16x16x32_bf16 v[68:71], v[144:147], v[164:167], 0
    ds_read_b64_tr_b16 v[184:185], v9 offset:4096
    buffer_load_dwordx4 v6, s[40:43], s74 offen offset:1024 lds
    v_mfma_f32_16x16x32_bf16 v[72:75], v[148:151], v[164:167], 0
    s_add_u32 m0, s76, 57344
    v_mfma_f32_16x16x32_bf16 v[76:79], v[152:155], v[164:167], 0
    ds_read_b64_tr_b16 v[186:187], v9 offset:4608
    s_mov_b32 s74, 442496
    v_mfma_f32_16x16x32_bf16 v[80:83], v[156:159], v[164:167], 0
    ds_read_b64_tr_b16 v[188:189], v10 offset:4096
    buffer_load_dwordx4 v5, s[40:43], s74 offen offset:0 lds
    s_waitcnt lgkmcnt(9)
    v_mfma_f32_16x16x32_bf16 v[84:87], v[136:139], v[168:171], 0
    ds_read_b64_tr_b16 v[190:191], v10 offset:4608
    v_mfma_f32_16x16x32_bf16 v[88:91], v[140:143], v[168:171], 0
    ds_read_b64_tr_b16 v[192:193], v11 offset:4096
    v_mfma_f32_16x16x32_bf16 v[92:95], v[144:147], v[168:171], 0
    ds_read_b64_tr_b16 v[194:195], v11 offset:4608
    buffer_load_dwordx4 v6, s[40:43], s74 offen offset:1024 lds
    v_mfma_f32_16x16x32_bf16 v[96:99], v[148:151], v[168:171], 0
    v_mfma_f32_16x16x32_bf16 v[100:103], v[152:155], v[168:171], 0
    ds_read_b64_tr_b16 v[196:197], v12 offset:4096
    s_add_u32 m0, s76, 65536
    v_mfma_f32_16x16x32_bf16 v[104:107], v[156:159], v[168:171], 0
    ds_read_b64_tr_b16 v[198:199], v12 offset:4608
    s_mov_b32 s74, 442624
    s_waitcnt lgkmcnt(13)
    v_mfma_f32_16x16x32_bf16 v[108:111], v[136:139], v[172:175], 0
    ds_read_b128 v[204:207], v134 offset:2048
    buffer_load_dwordx4 v5, s[40:43], s74 offen offset:0 lds
    v_mfma_f32_16x16x32_bf16 v[112:115], v[140:143], v[172:175], 0
    ds_read_b128 v[208:211], v134 offset:4096
    v_mfma_f32_16x16x32_bf16 v[116:119], v[144:147], v[172:175], 0
    ds_read_b128 v[212:215], v134 offset:6144
    v_mfma_f32_16x16x32_bf16 v[120:123], v[148:151], v[172:175], 0
    buffer_load_dwordx4 v6, s[40:43], s74 offen offset:1024 lds
    v_mfma_f32_16x16x32_bf16 v[124:127], v[152:155], v[172:175], 0
    v_mfma_f32_16x16x32_bf16 v[128:131], v[156:159], v[172:175], 0
    s_waitcnt vmcnt(7) lgkmcnt(0)
    s_barrier
    v_mfma_f32_16x16x32_bf16 v[36:39], v[176:179], v[200:203], v[36:39]
    ds_read_b128 v[160:163], v13 offset:16384
    s_add_u32 m0, s75, 32768
    s_movk_i32 s73, 256
    v_mfma_f32_16x16x32_bf16 v[40:43], v[180:183], v[200:203], v[40:43]
    buffer_load_dwordx4 v1, s[28:31], s73 offen offset:0 lds
    v_mfma_f32_16x16x32_bf16 v[44:47], v[184:187], v[200:203], v[44:47]
    ds_read_b64_tr_b16 v[136:137], v7 offset:24576
    v_mfma_f32_16x16x32_bf16 v[48:51], v[188:191], v[200:203], v[48:51]
    ds_read_b64_tr_b16 v[138:139], v7 offset:25088
    v_mfma_f32_16x16x32_bf16 v[52:55], v[192:195], v[200:203], v[52:55]
    ds_read_b64_tr_b16 v[140:141], v8 offset:24576
    v_mfma_f32_16x16x32_bf16 v[56:59], v[196:199], v[200:203], v[56:59]
    buffer_load_dwordx4 v2, s[28:31], s73 offen offset:1024 lds
    v_mfma_f32_16x16x32_bf16 v[60:63], v[176:179], v[204:207], v[60:63]
    ds_read_b64_tr_b16 v[142:143], v8 offset:25088
    v_mfma_f32_16x16x32_bf16 v[64:67], v[180:183], v[204:207], v[64:67]
    ds_read_b64_tr_b16 v[144:145], v9 offset:24576
    v_mfma_f32_16x16x32_bf16 v[68:71], v[184:187], v[204:207], v[68:71]
    ds_read_b64_tr_b16 v[146:147], v9 offset:25088
    v_mfma_f32_16x16x32_bf16 v[72:75], v[188:191], v[204:207], v[72:75]
    buffer_load_dwordx4 v3, s[28:31], s73 offen offset:2048 lds
    v_mfma_f32_16x16x32_bf16 v[76:79], v[192:195], v[204:207], v[76:79]
    ds_read_b64_tr_b16 v[148:149], v10 offset:24576
    v_mfma_f32_16x16x32_bf16 v[80:83], v[196:199], v[204:207], v[80:83]
    ds_read_b64_tr_b16 v[150:151], v10 offset:25088
    v_mfma_f32_16x16x32_bf16 v[84:87], v[176:179], v[208:211], v[84:87]
    ds_read_b64_tr_b16 v[152:153], v11 offset:24576
    v_mfma_f32_16x16x32_bf16 v[88:91], v[180:183], v[208:211], v[88:91]
    buffer_load_dwordx4 v4, s[28:31], s73 offen offset:3072 lds
    v_mfma_f32_16x16x32_bf16 v[92:95], v[184:187], v[208:211], v[92:95]
    ds_read_b64_tr_b16 v[154:155], v11 offset:25088
    v_mfma_f32_16x16x32_bf16 v[96:99], v[188:191], v[208:211], v[96:99]
    ds_read_b64_tr_b16 v[156:157], v12 offset:24576
    s_add_u32 m0, s76, 0
    v_mfma_f32_16x16x32_bf16 v[100:103], v[192:195], v[208:211], v[100:103]
    ds_read_b64_tr_b16 v[158:159], v12 offset:25088
    s_mov_b32 s74, 663552
    v_mfma_f32_16x16x32_bf16 v[104:107], v[196:199], v[208:211], v[104:107]
    buffer_load_dwordx4 v5, s[40:43], s74 offen offset:0 lds
    v_mfma_f32_16x16x32_bf16 v[108:111], v[176:179], v[212:215], v[108:111]
    ds_read_b128 v[164:167], v13 offset:18432
    v_mfma_f32_16x16x32_bf16 v[112:115], v[180:183], v[212:215], v[112:115]
    ds_read_b128 v[168:171], v13 offset:20480
    v_mfma_f32_16x16x32_bf16 v[116:119], v[184:187], v[212:215], v[116:119]
    ds_read_b128 v[172:175], v13 offset:22528
    v_mfma_f32_16x16x32_bf16 v[120:123], v[188:191], v[212:215], v[120:123]
    buffer_load_dwordx4 v6, s[40:43], s74 offen offset:1024 lds
    v_mfma_f32_16x16x32_bf16 v[124:127], v[192:195], v[212:215], v[124:127]
    v_mfma_f32_16x16x32_bf16 v[128:131], v[196:199], v[212:215], v[128:131]
    s_waitcnt lgkmcnt(0)
    v_mfma_f32_16x16x32_bf16 v[36:39], v[136:139], v[160:163], v[36:39]
    ds_read_b128 v[200:203], v134 offset:16384
    s_add_u32 m0, s76, 8192
    s_mov_b32 s74, 663680
    v_mfma_f32_16x16x32_bf16 v[40:43], v[140:143], v[160:163], v[40:43]
    buffer_load_dwordx4 v5, s[40:43], s74 offen offset:0 lds
    v_mfma_f32_16x16x32_bf16 v[44:47], v[144:147], v[160:163], v[44:47]
    ds_read_b64_tr_b16 v[176:177], v7 offset:28672
    v_mfma_f32_16x16x32_bf16 v[48:51], v[148:151], v[160:163], v[48:51]
    ds_read_b64_tr_b16 v[178:179], v7 offset:29184
    v_mfma_f32_16x16x32_bf16 v[52:55], v[152:155], v[160:163], v[52:55]
    ds_read_b64_tr_b16 v[180:181], v8 offset:28672
    v_mfma_f32_16x16x32_bf16 v[56:59], v[156:159], v[160:163], v[56:59]
    buffer_load_dwordx4 v6, s[40:43], s74 offen offset:1024 lds
    v_mfma_f32_16x16x32_bf16 v[60:63], v[136:139], v[164:167], v[60:63]
    ds_read_b64_tr_b16 v[182:183], v8 offset:29184
    v_mfma_f32_16x16x32_bf16 v[64:67], v[140:143], v[164:167], v[64:67]
    ds_read_b64_tr_b16 v[184:185], v9 offset:28672
    s_add_u32 m0, s76, 16384
    v_mfma_f32_16x16x32_bf16 v[68:71], v[144:147], v[164:167], v[68:71]
    ds_read_b64_tr_b16 v[186:187], v9 offset:29184
    s_mov_b32 s74, 663808
    v_mfma_f32_16x16x32_bf16 v[72:75], v[148:151], v[164:167], v[72:75]
    buffer_load_dwordx4 v5, s[40:43], s74 offen offset:0 lds
    v_mfma_f32_16x16x32_bf16 v[76:79], v[152:155], v[164:167], v[76:79]
    ds_read_b64_tr_b16 v[188:189], v10 offset:28672
    v_mfma_f32_16x16x32_bf16 v[80:83], v[156:159], v[164:167], v[80:83]
    ds_read_b64_tr_b16 v[190:191], v10 offset:29184
    v_mfma_f32_16x16x32_bf16 v[84:87], v[136:139], v[168:171], v[84:87]
    ds_read_b64_tr_b16 v[192:193], v11 offset:28672
    v_mfma_f32_16x16x32_bf16 v[88:91], v[140:143], v[168:171], v[88:91]
    buffer_load_dwordx4 v6, s[40:43], s74 offen offset:1024 lds
    v_mfma_f32_16x16x32_bf16 v[92:95], v[144:147], v[168:171], v[92:95]
    ds_read_b64_tr_b16 v[194:195], v11 offset:29184
    v_mfma_f32_16x16x32_bf16 v[96:99], v[148:151], v[168:171], v[96:99]
    ds_read_b64_tr_b16 v[196:197], v12 offset:28672
    s_add_u32 m0, s75, 0
    v_mfma_f32_16x16x32_bf16 v[100:103], v[152:155], v[168:171], v[100:103]
    ds_read_b64_tr_b16 v[198:199], v12 offset:29184
    s_movk_i32 s73, 384
    v_mfma_f32_16x16x32_bf16 v[104:107], v[156:159], v[168:171], v[104:107]
    buffer_load_dwordx4 v1, s[28:31], s73 offen offset:0 lds
    v_mfma_f32_16x16x32_bf16 v[108:111], v[136:139], v[172:175], v[108:111]
    ds_read_b128 v[204:207], v134 offset:18432
    v_mfma_f32_16x16x32_bf16 v[112:115], v[140:143], v[172:175], v[112:115]
    ds_read_b128 v[208:211], v134 offset:20480
    v_mfma_f32_16x16x32_bf16 v[116:119], v[144:147], v[172:175], v[116:119]
    ds_read_b128 v[212:215], v134 offset:22528
    v_mfma_f32_16x16x32_bf16 v[120:123], v[148:151], v[172:175], v[120:123]
    buffer_load_dwordx4 v2, s[28:31], s73 offen offset:1024 lds
    v_mfma_f32_16x16x32_bf16 v[124:127], v[152:155], v[172:175], v[124:127]
    v_mfma_f32_16x16x32_bf16 v[128:131], v[156:159], v[172:175], v[128:131]
    s_waitcnt vmcnt(8) lgkmcnt(0)
    s_barrier
    v_mfma_f32_16x16x32_bf16 v[36:39], v[176:179], v[200:203], v[36:39]
    ds_read_b128 v[160:163], v13 offset:32768
    v_mfma_f32_16x16x32_bf16 v[40:43], v[180:183], v[200:203], v[40:43]
    buffer_load_dwordx4 v3, s[28:31], s73 offen offset:2048 lds
    v_mfma_f32_16x16x32_bf16 v[44:47], v[184:187], v[200:203], v[44:47]
    ds_read_b64_tr_b16 v[136:137], v7 offset:49152
    v_mfma_f32_16x16x32_bf16 v[48:51], v[188:191], v[200:203], v[48:51]
    ds_read_b64_tr_b16 v[138:139], v7 offset:49664
    v_mfma_f32_16x16x32_bf16 v[52:55], v[192:195], v[200:203], v[52:55]
    ds_read_b64_tr_b16 v[140:141], v8 offset:49152
    v_mfma_f32_16x16x32_bf16 v[56:59], v[196:199], v[200:203], v[56:59]
    buffer_load_dwordx4 v4, s[28:31], s73 offen offset:3072 lds
    v_mfma_f32_16x16x32_bf16 v[60:63], v[176:179], v[204:207], v[60:63]
    ds_read_b64_tr_b16 v[142:143], v8 offset:49664
    v_mfma_f32_16x16x32_bf16 v[64:67], v[180:183], v[204:207], v[64:67]
    ds_read_b64_tr_b16 v[144:145], v9 offset:49152
    s_add_u32 m0, s76, 24576
    v_mfma_f32_16x16x32_bf16 v[68:71], v[184:187], v[204:207], v[68:71]
    ds_read_b64_tr_b16 v[146:147], v9 offset:49664
    s_mov_b32 s74, 884736
    v_mfma_f32_16x16x32_bf16 v[72:75], v[188:191], v[204:207], v[72:75]
    buffer_load_dwordx4 v5, s[40:43], s74 offen offset:0 lds
    v_mfma_f32_16x16x32_bf16 v[76:79], v[192:195], v[204:207], v[76:79]
    ds_read_b64_tr_b16 v[148:149], v10 offset:49152
    v_mfma_f32_16x16x32_bf16 v[80:83], v[196:199], v[204:207], v[80:83]
    ds_read_b64_tr_b16 v[150:151], v10 offset:49664
    v_mfma_f32_16x16x32_bf16 v[84:87], v[176:179], v[208:211], v[84:87]
    ds_read_b64_tr_b16 v[152:153], v11 offset:49152
    v_mfma_f32_16x16x32_bf16 v[88:91], v[180:183], v[208:211], v[88:91]
    buffer_load_dwordx4 v6, s[40:43], s74 offen offset:1024 lds
    v_mfma_f32_16x16x32_bf16 v[92:95], v[184:187], v[208:211], v[92:95]
    ds_read_b64_tr_b16 v[154:155], v11 offset:49664
    v_mfma_f32_16x16x32_bf16 v[96:99], v[188:191], v[208:211], v[96:99]
    ds_read_b64_tr_b16 v[156:157], v12 offset:49152
    s_add_u32 m0, s76, 32768
    v_mfma_f32_16x16x32_bf16 v[100:103], v[192:195], v[208:211], v[100:103]
    ds_read_b64_tr_b16 v[158:159], v12 offset:49664
    s_mov_b32 s74, 884864
    v_mfma_f32_16x16x32_bf16 v[104:107], v[196:199], v[208:211], v[104:107]
    buffer_load_dwordx4 v5, s[40:43], s74 offen offset:0 lds
    v_mfma_f32_16x16x32_bf16 v[108:111], v[176:179], v[212:215], v[108:111]
    ds_read_b128 v[164:167], v13 offset:34816
    v_mfma_f32_16x16x32_bf16 v[112:115], v[180:183], v[212:215], v[112:115]
    ds_read_b128 v[168:171], v13 offset:36864
    v_mfma_f32_16x16x32_bf16 v[116:119], v[184:187], v[212:215], v[116:119]
    ds_read_b128 v[172:175], v13 offset:38912
    v_mfma_f32_16x16x32_bf16 v[120:123], v[188:191], v[212:215], v[120:123]
    buffer_load_dwordx4 v6, s[40:43], s74 offen offset:1024 lds
    v_mfma_f32_16x16x32_bf16 v[124:127], v[192:195], v[212:215], v[124:127]
    v_mfma_f32_16x16x32_bf16 v[128:131], v[196:199], v[212:215], v[128:131]
    s_waitcnt lgkmcnt(0)
    v_mfma_f32_16x16x32_bf16 v[36:39], v[136:139], v[160:163], v[36:39]
    ds_read_b128 v[200:203], v134 offset:32768
    s_add_u32 m0, s76, 40960
    s_mov_b32 s74, 884992
    v_mfma_f32_16x16x32_bf16 v[40:43], v[140:143], v[160:163], v[40:43]
    buffer_load_dwordx4 v5, s[40:43], s74 offen offset:0 lds
    v_mfma_f32_16x16x32_bf16 v[44:47], v[144:147], v[160:163], v[44:47]
    ds_read_b64_tr_b16 v[176:177], v7 offset:53248
    v_mfma_f32_16x16x32_bf16 v[48:51], v[148:151], v[160:163], v[48:51]
    ds_read_b64_tr_b16 v[178:179], v7 offset:53760
    v_mfma_f32_16x16x32_bf16 v[52:55], v[152:155], v[160:163], v[52:55]
    ds_read_b64_tr_b16 v[180:181], v8 offset:53248
    v_mfma_f32_16x16x32_bf16 v[56:59], v[156:159], v[160:163], v[56:59]
    buffer_load_dwordx4 v6, s[40:43], s74 offen offset:1024 lds
    v_mfma_f32_16x16x32_bf16 v[60:63], v[136:139], v[164:167], v[60:63]
    ds_read_b64_tr_b16 v[182:183], v8 offset:53760
    v_mfma_f32_16x16x32_bf16 v[64:67], v[140:143], v[164:167], v[64:67]
    ds_read_b64_tr_b16 v[184:185], v9 offset:53248
    s_add_u32 m0, s75, 16384
    v_mfma_f32_16x16x32_bf16 v[68:71], v[144:147], v[164:167], v[68:71]
    ds_read_b64_tr_b16 v[186:187], v9 offset:53760
    s_movk_i32 s73, 512
    v_mfma_f32_16x16x32_bf16 v[72:75], v[148:151], v[164:167], v[72:75]
    buffer_load_dwordx4 v1, s[28:31], s73 offen offset:0 lds
    v_mfma_f32_16x16x32_bf16 v[76:79], v[152:155], v[164:167], v[76:79]
    ds_read_b64_tr_b16 v[188:189], v10 offset:53248
    v_mfma_f32_16x16x32_bf16 v[80:83], v[156:159], v[164:167], v[80:83]
    ds_read_b64_tr_b16 v[190:191], v10 offset:53760
    v_mfma_f32_16x16x32_bf16 v[84:87], v[136:139], v[168:171], v[84:87]
    ds_read_b64_tr_b16 v[192:193], v11 offset:53248
    v_mfma_f32_16x16x32_bf16 v[88:91], v[140:143], v[168:171], v[88:91]
    buffer_load_dwordx4 v2, s[28:31], s73 offen offset:1024 lds
    v_mfma_f32_16x16x32_bf16 v[92:95], v[144:147], v[168:171], v[92:95]
    ds_read_b64_tr_b16 v[194:195], v11 offset:53760
    v_mfma_f32_16x16x32_bf16 v[96:99], v[148:151], v[168:171], v[96:99]
    ds_read_b64_tr_b16 v[196:197], v12 offset:53248
    v_mfma_f32_16x16x32_bf16 v[100:103], v[152:155], v[168:171], v[100:103]
    ds_read_b64_tr_b16 v[198:199], v12 offset:53760
    v_mfma_f32_16x16x32_bf16 v[104:107], v[156:159], v[168:171], v[104:107]
    buffer_load_dwordx4 v3, s[28:31], s73 offen offset:2048 lds
    v_mfma_f32_16x16x32_bf16 v[108:111], v[136:139], v[172:175], v[108:111]
    ds_read_b128 v[204:207], v134 offset:34816
    v_mfma_f32_16x16x32_bf16 v[112:115], v[140:143], v[172:175], v[112:115]
    ds_read_b128 v[208:211], v134 offset:36864
    v_mfma_f32_16x16x32_bf16 v[116:119], v[144:147], v[172:175], v[116:119]
    ds_read_b128 v[212:215], v134 offset:38912
    v_mfma_f32_16x16x32_bf16 v[120:123], v[148:151], v[172:175], v[120:123]
    buffer_load_dwordx4 v4, s[28:31], s73 offen offset:3072 lds
    v_mfma_f32_16x16x32_bf16 v[124:127], v[152:155], v[172:175], v[124:127]
    v_mfma_f32_16x16x32_bf16 v[128:131], v[156:159], v[172:175], v[128:131]
    s_waitcnt vmcnt(10) lgkmcnt(0)
    s_barrier
    v_mfma_f32_16x16x32_bf16 v[36:39], v[176:179], v[200:203], v[36:39]
    ds_read_b128 v[160:163], v13 offset:0
    s_add_u32 m0, s76, 49152
    s_mov_b32 s74, 1105920
    v_mfma_f32_16x16x32_bf16 v[40:43], v[180:183], v[200:203], v[40:43]
    buffer_load_dwordx4 v5, s[40:43], s74 offen offset:0 lds
    v_mfma_f32_16x16x32_bf16 v[44:47], v[184:187], v[200:203], v[44:47]
    ds_read_b64_tr_b16 v[136:137], v7 offset:0
    v_mfma_f32_16x16x32_bf16 v[48:51], v[188:191], v[200:203], v[48:51]
    ds_read_b64_tr_b16 v[138:139], v7 offset:512
    v_mfma_f32_16x16x32_bf16 v[52:55], v[192:195], v[200:203], v[52:55]
    ds_read_b64_tr_b16 v[140:141], v8 offset:0
    v_mfma_f32_16x16x32_bf16 v[56:59], v[196:199], v[200:203], v[56:59]
    ds_read_b64_tr_b16 v[142:143], v8 offset:512
    v_mfma_f32_16x16x32_bf16 v[60:63], v[176:179], v[204:207], v[60:63]
    buffer_load_dwordx4 v6, s[40:43], s74 offen offset:1024 lds
    v_mfma_f32_16x16x32_bf16 v[64:67], v[180:183], v[204:207], v[64:67]
    ds_read_b64_tr_b16 v[144:145], v9 offset:0
    v_mfma_f32_16x16x32_bf16 v[68:71], v[184:187], v[204:207], v[68:71]
    ds_read_b64_tr_b16 v[146:147], v9 offset:512
    v_mfma_f32_16x16x32_bf16 v[72:75], v[188:191], v[204:207], v[72:75]
    ds_read_b64_tr_b16 v[148:149], v10 offset:0
    s_add_u32 m0, s76, 57344
    v_mfma_f32_16x16x32_bf16 v[76:79], v[192:195], v[204:207], v[76:79]
    ds_read_b64_tr_b16 v[150:151], v10 offset:512
    s_mov_b32 s74, 1106048
    v_mfma_f32_16x16x32_bf16 v[80:83], v[196:199], v[204:207], v[80:83]
    buffer_load_dwordx4 v5, s[40:43], s74 offen offset:0 lds
    v_mfma_f32_16x16x32_bf16 v[84:87], v[176:179], v[208:211], v[84:87]
    ds_read_b64_tr_b16 v[152:153], v11 offset:0
    v_mfma_f32_16x16x32_bf16 v[88:91], v[180:183], v[208:211], v[88:91]
    ds_read_b64_tr_b16 v[154:155], v11 offset:512
    v_mfma_f32_16x16x32_bf16 v[92:95], v[184:187], v[208:211], v[92:95]
    ds_read_b64_tr_b16 v[156:157], v12 offset:0
    v_mfma_f32_16x16x32_bf16 v[96:99], v[188:191], v[208:211], v[96:99]
    ds_read_b64_tr_b16 v[158:159], v12 offset:512
    v_mfma_f32_16x16x32_bf16 v[100:103], v[192:195], v[208:211], v[100:103]
    buffer_load_dwordx4 v6, s[40:43], s74 offen offset:1024 lds
    v_mfma_f32_16x16x32_bf16 v[104:107], v[196:199], v[208:211], v[104:107]
    ds_read_b128 v[164:167], v13 offset:2048
    v_mfma_f32_16x16x32_bf16 v[108:111], v[176:179], v[212:215], v[108:111]
    ds_read_b128 v[168:171], v13 offset:4096
    s_add_u32 m0, s76, 65536
    v_mfma_f32_16x16x32_bf16 v[112:115], v[180:183], v[212:215], v[112:115]
    ds_read_b128 v[172:175], v13 offset:6144
    s_mov_b32 s74, 1106176
    v_mfma_f32_16x16x32_bf16 v[116:119], v[184:187], v[212:215], v[116:119]
    buffer_load_dwordx4 v5, s[40:43], s74 offen offset:0 lds
    v_mfma_f32_16x16x32_bf16 v[120:123], v[188:191], v[212:215], v[120:123]
    v_mfma_f32_16x16x32_bf16 v[124:127], v[192:195], v[212:215], v[124:127]
    v_mfma_f32_16x16x32_bf16 v[128:131], v[196:199], v[212:215], v[128:131]
    s_waitcnt lgkmcnt(0)
    v_mfma_f32_16x16x32_bf16 v[36:39], v[136:139], v[160:163], v[36:39]
    ds_read_b128 v[200:203], v134 offset:0
    v_mfma_f32_16x16x32_bf16 v[40:43], v[140:143], v[160:163], v[40:43]
    buffer_load_dwordx4 v6, s[40:43], s74 offen offset:1024 lds
    v_mfma_f32_16x16x32_bf16 v[44:47], v[144:147], v[160:163], v[44:47]
    ds_read_b64_tr_b16 v[176:177], v7 offset:4096
    v_mfma_f32_16x16x32_bf16 v[48:51], v[148:151], v[160:163], v[48:51]
    ds_read_b64_tr_b16 v[178:179], v7 offset:4608
    v_mfma_f32_16x16x32_bf16 v[52:55], v[152:155], v[160:163], v[52:55]
    ds_read_b64_tr_b16 v[180:181], v8 offset:4096
    s_add_u32 m0, s75, 32768
    v_mfma_f32_16x16x32_bf16 v[56:59], v[156:159], v[160:163], v[56:59]
    ds_read_b64_tr_b16 v[182:183], v8 offset:4608
    s_movk_i32 s73, 640
    v_mfma_f32_16x16x32_bf16 v[60:63], v[136:139], v[164:167], v[60:63]
    buffer_load_dwordx4 v1, s[28:31], s73 offen offset:0 lds
    v_mfma_f32_16x16x32_bf16 v[64:67], v[140:143], v[164:167], v[64:67]
    ds_read_b64_tr_b16 v[184:185], v9 offset:4096
    v_mfma_f32_16x16x32_bf16 v[68:71], v[144:147], v[164:167], v[68:71]
    ds_read_b64_tr_b16 v[186:187], v9 offset:4608
    v_mfma_f32_16x16x32_bf16 v[72:75], v[148:151], v[164:167], v[72:75]
    ds_read_b64_tr_b16 v[188:189], v10 offset:4096
    v_mfma_f32_16x16x32_bf16 v[76:79], v[152:155], v[164:167], v[76:79]
    ds_read_b64_tr_b16 v[190:191], v10 offset:4608
    v_mfma_f32_16x16x32_bf16 v[80:83], v[156:159], v[164:167], v[80:83]
    buffer_load_dwordx4 v2, s[28:31], s73 offen offset:1024 lds
    v_mfma_f32_16x16x32_bf16 v[84:87], v[136:139], v[168:171], v[84:87]
    ds_read_b64_tr_b16 v[192:193], v11 offset:4096
    v_mfma_f32_16x16x32_bf16 v[88:91], v[140:143], v[168:171], v[88:91]
    ds_read_b64_tr_b16 v[194:195], v11 offset:4608
    v_mfma_f32_16x16x32_bf16 v[92:95], v[144:147], v[168:171], v[92:95]
    ds_read_b64_tr_b16 v[196:197], v12 offset:4096
    v_mfma_f32_16x16x32_bf16 v[96:99], v[148:151], v[168:171], v[96:99]
    ds_read_b64_tr_b16 v[198:199], v12 offset:4608
    v_mfma_f32_16x16x32_bf16 v[100:103], v[152:155], v[168:171], v[100:103]
    buffer_load_dwordx4 v3, s[28:31], s73 offen offset:2048 lds
    v_mfma_f32_16x16x32_bf16 v[104:107], v[156:159], v[168:171], v[104:107]
    ds_read_b128 v[204:207], v134 offset:2048
    v_mfma_f32_16x16x32_bf16 v[108:111], v[136:139], v[172:175], v[108:111]
    ds_read_b128 v[208:211], v134 offset:4096
    v_mfma_f32_16x16x32_bf16 v[112:115], v[140:143], v[172:175], v[112:115]
    ds_read_b128 v[212:215], v134 offset:6144
    v_mfma_f32_16x16x32_bf16 v[116:119], v[144:147], v[172:175], v[116:119]
    buffer_load_dwordx4 v4, s[28:31], s73 offen offset:3072 lds
    v_mfma_f32_16x16x32_bf16 v[120:123], v[148:151], v[172:175], v[120:123]
    v_mfma_f32_16x16x32_bf16 v[124:127], v[152:155], v[172:175], v[124:127]
    v_mfma_f32_16x16x32_bf16 v[128:131], v[156:159], v[172:175], v[128:131]
    s_waitcnt vmcnt(10) lgkmcnt(0)
    s_barrier
    v_mfma_f32_16x16x32_bf16 v[36:39], v[176:179], v[200:203], v[36:39]
    ds_read_b128 v[160:163], v13 offset:16384
    s_add_u32 m0, s76, 0
    s_mov_b32 s74, 1327104
    v_mfma_f32_16x16x32_bf16 v[40:43], v[180:183], v[200:203], v[40:43]
    buffer_load_dwordx4 v5, s[40:43], s74 offen offset:0 lds
    v_mfma_f32_16x16x32_bf16 v[44:47], v[184:187], v[200:203], v[44:47]
    ds_read_b64_tr_b16 v[136:137], v7 offset:24576
    v_mfma_f32_16x16x32_bf16 v[48:51], v[188:191], v[200:203], v[48:51]
    ds_read_b64_tr_b16 v[138:139], v7 offset:25088
    v_mfma_f32_16x16x32_bf16 v[52:55], v[192:195], v[200:203], v[52:55]
    ds_read_b64_tr_b16 v[140:141], v8 offset:24576
    v_mfma_f32_16x16x32_bf16 v[56:59], v[196:199], v[200:203], v[56:59]
    ds_read_b64_tr_b16 v[142:143], v8 offset:25088
    v_mfma_f32_16x16x32_bf16 v[60:63], v[176:179], v[204:207], v[60:63]
    buffer_load_dwordx4 v6, s[40:43], s74 offen offset:1024 lds
    v_mfma_f32_16x16x32_bf16 v[64:67], v[180:183], v[204:207], v[64:67]
    ds_read_b64_tr_b16 v[144:145], v9 offset:24576
    v_mfma_f32_16x16x32_bf16 v[68:71], v[184:187], v[204:207], v[68:71]
    ds_read_b64_tr_b16 v[146:147], v9 offset:25088
    v_mfma_f32_16x16x32_bf16 v[72:75], v[188:191], v[204:207], v[72:75]
    ds_read_b64_tr_b16 v[148:149], v10 offset:24576
    s_add_u32 m0, s76, 8192
    v_mfma_f32_16x16x32_bf16 v[76:79], v[192:195], v[204:207], v[76:79]
    ds_read_b64_tr_b16 v[150:151], v10 offset:25088
    s_mov_b32 s74, 1327232
    v_mfma_f32_16x16x32_bf16 v[80:83], v[196:199], v[204:207], v[80:83]
    buffer_load_dwordx4 v5, s[40:43], s74 offen offset:0 lds
    v_mfma_f32_16x16x32_bf16 v[84:87], v[176:179], v[208:211], v[84:87]
    ds_read_b64_tr_b16 v[152:153], v11 offset:24576
    v_mfma_f32_16x16x32_bf16 v[88:91], v[180:183], v[208:211], v[88:91]
    ds_read_b64_tr_b16 v[154:155], v11 offset:25088
    v_mfma_f32_16x16x32_bf16 v[92:95], v[184:187], v[208:211], v[92:95]
    ds_read_b64_tr_b16 v[156:157], v12 offset:24576
    v_mfma_f32_16x16x32_bf16 v[96:99], v[188:191], v[208:211], v[96:99]
    ds_read_b64_tr_b16 v[158:159], v12 offset:25088
    v_mfma_f32_16x16x32_bf16 v[100:103], v[192:195], v[208:211], v[100:103]
    buffer_load_dwordx4 v6, s[40:43], s74 offen offset:1024 lds
    v_mfma_f32_16x16x32_bf16 v[104:107], v[196:199], v[208:211], v[104:107]
    ds_read_b128 v[164:167], v13 offset:18432
    v_mfma_f32_16x16x32_bf16 v[108:111], v[176:179], v[212:215], v[108:111]
    ds_read_b128 v[168:171], v13 offset:20480
    s_add_u32 m0, s76, 16384
    v_mfma_f32_16x16x32_bf16 v[112:115], v[180:183], v[212:215], v[112:115]
    ds_read_b128 v[172:175], v13 offset:22528
    s_mov_b32 s74, 1327360
    v_mfma_f32_16x16x32_bf16 v[116:119], v[184:187], v[212:215], v[116:119]
    buffer_load_dwordx4 v5, s[40:43], s74 offen offset:0 lds
    v_mfma_f32_16x16x32_bf16 v[120:123], v[188:191], v[212:215], v[120:123]
    v_mfma_f32_16x16x32_bf16 v[124:127], v[192:195], v[212:215], v[124:127]
    v_mfma_f32_16x16x32_bf16 v[128:131], v[196:199], v[212:215], v[128:131]
    s_waitcnt lgkmcnt(0)
    v_mfma_f32_16x16x32_bf16 v[36:39], v[136:139], v[160:163], v[36:39]
    ds_read_b128 v[200:203], v134 offset:16384
    v_mfma_f32_16x16x32_bf16 v[40:43], v[140:143], v[160:163], v[40:43]
    buffer_load_dwordx4 v6, s[40:43], s74 offen offset:1024 lds
    v_mfma_f32_16x16x32_bf16 v[44:47], v[144:147], v[160:163], v[44:47]
    ds_read_b64_tr_b16 v[176:177], v7 offset:28672
    v_mfma_f32_16x16x32_bf16 v[48:51], v[148:151], v[160:163], v[48:51]
    ds_read_b64_tr_b16 v[178:179], v7 offset:29184
    v_mfma_f32_16x16x32_bf16 v[52:55], v[152:155], v[160:163], v[52:55]
    ds_read_b64_tr_b16 v[180:181], v8 offset:28672
    s_add_u32 m0, s75, 0
    v_mfma_f32_16x16x32_bf16 v[56:59], v[156:159], v[160:163], v[56:59]
    ds_read_b64_tr_b16 v[182:183], v8 offset:29184
    s_movk_i32 s73, 768
    v_mfma_f32_16x16x32_bf16 v[60:63], v[136:139], v[164:167], v[60:63]
    buffer_load_dwordx4 v1, s[28:31], s73 offen offset:0 lds
    v_mfma_f32_16x16x32_bf16 v[64:67], v[140:143], v[164:167], v[64:67]
    ds_read_b64_tr_b16 v[184:185], v9 offset:28672
    v_mfma_f32_16x16x32_bf16 v[68:71], v[144:147], v[164:167], v[68:71]
    ds_read_b64_tr_b16 v[186:187], v9 offset:29184
    v_mfma_f32_16x16x32_bf16 v[72:75], v[148:151], v[164:167], v[72:75]
    ds_read_b64_tr_b16 v[188:189], v10 offset:28672
    v_mfma_f32_16x16x32_bf16 v[76:79], v[152:155], v[164:167], v[76:79]
    ds_read_b64_tr_b16 v[190:191], v10 offset:29184
    v_mfma_f32_16x16x32_bf16 v[80:83], v[156:159], v[164:167], v[80:83]
    buffer_load_dwordx4 v2, s[28:31], s73 offen offset:1024 lds
    v_mfma_f32_16x16x32_bf16 v[84:87], v[136:139], v[168:171], v[84:87]
    ds_read_b64_tr_b16 v[192:193], v11 offset:28672
    v_mfma_f32_16x16x32_bf16 v[88:91], v[140:143], v[168:171], v[88:91]
    ds_read_b64_tr_b16 v[194:195], v11 offset:29184
    v_mfma_f32_16x16x32_bf16 v[92:95], v[144:147], v[168:171], v[92:95]
    ds_read_b64_tr_b16 v[196:197], v12 offset:28672
    v_mfma_f32_16x16x32_bf16 v[96:99], v[148:151], v[168:171], v[96:99]
    ds_read_b64_tr_b16 v[198:199], v12 offset:29184
    v_mfma_f32_16x16x32_bf16 v[100:103], v[152:155], v[168:171], v[100:103]
    buffer_load_dwordx4 v3, s[28:31], s73 offen offset:2048 lds
    v_mfma_f32_16x16x32_bf16 v[104:107], v[156:159], v[168:171], v[104:107]
    ds_read_b128 v[204:207], v134 offset:18432
    v_mfma_f32_16x16x32_bf16 v[108:111], v[136:139], v[172:175], v[108:111]
    ds_read_b128 v[208:211], v134 offset:20480
    v_mfma_f32_16x16x32_bf16 v[112:115], v[140:143], v[172:175], v[112:115]
    ds_read_b128 v[212:215], v134 offset:22528
    v_mfma_f32_16x16x32_bf16 v[116:119], v[144:147], v[172:175], v[116:119]
    buffer_load_dwordx4 v4, s[28:31], s73 offen offset:3072 lds
    v_mfma_f32_16x16x32_bf16 v[120:123], v[148:151], v[172:175], v[120:123]
    v_mfma_f32_16x16x32_bf16 v[124:127], v[152:155], v[172:175], v[124:127]
    v_mfma_f32_16x16x32_bf16 v[128:131], v[156:159], v[172:175], v[128:131]
    s_waitcnt vmcnt(10) lgkmcnt(0)
    s_barrier
    v_mfma_f32_16x16x32_bf16 v[36:39], v[176:179], v[200:203], v[36:39]
    ds_read_b128 v[160:163], v13 offset:32768
    s_add_u32 m0, s76, 24576
    s_mov_b32 s74, 1548288
    v_mfma_f32_16x16x32_bf16 v[40:43], v[180:183], v[200:203], v[40:43]
    buffer_load_dwordx4 v5, s[40:43], s74 offen offset:0 lds
    v_mfma_f32_16x16x32_bf16 v[44:47], v[184:187], v[200:203], v[44:47]
    ds_read_b64_tr_b16 v[136:137], v7 offset:49152
    v_mfma_f32_16x16x32_bf16 v[48:51], v[188:191], v[200:203], v[48:51]
    ds_read_b64_tr_b16 v[138:139], v7 offset:49664
    v_mfma_f32_16x16x32_bf16 v[52:55], v[192:195], v[200:203], v[52:55]
    ds_read_b64_tr_b16 v[140:141], v8 offset:49152
    v_mfma_f32_16x16x32_bf16 v[56:59], v[196:199], v[200:203], v[56:59]
    ds_read_b64_tr_b16 v[142:143], v8 offset:49664
    v_mfma_f32_16x16x32_bf16 v[60:63], v[176:179], v[204:207], v[60:63]
    buffer_load_dwordx4 v6, s[40:43], s74 offen offset:1024 lds
L_st1:
    s_cbranch_execz L_wb_G
    v_mfma_f32_16x16x32_bf16 v[64:67], v[180:183], v[204:207], v[64:67]
    ds_read_b64_tr_b16 v[144:145], v9 offset:49152
    v_mfma_f32_16x16x32_bf16 v[68:71], v[184:187], v[204:207], v[68:71]
    ds_read_b64_tr_b16 v[146:147], v9 offset:49664
    v_mfma_f32_16x16x32_bf16 v[72:75], v[188:191], v[204:207], v[72:75]
    ds_read_b64_tr_b16 v[148:149], v10 offset:49152
    s_add_u32 m0, s76, 32768
    v_mfma_f32_16x16x32_bf16 v[76:79], v[192:195], v[204:207], v[76:79]
    ds_read_b64_tr_b16 v[150:151], v10 offset:49664
    s_mov_b32 s74, 1548416
    v_mfma_f32_16x16x32_bf16 v[80:83], v[196:199], v[204:207], v[80:83]
    buffer_load_dwordx4 v5, s[40:43], s74 offen offset:0 lds
    v_mfma_f32_16x16x32_bf16 v[84:87], v[176:179], v[208:211], v[84:87]
    ds_read_b64_tr_b16 v[152:153], v11 offset:49152
    v_mfma_f32_16x16x32_bf16 v[88:91], v[180:183], v[208:211], v[88:91]
    ds_read_b64_tr_b16 v[154:155], v11 offset:49664
    v_mfma_f32_16x16x32_bf16 v[92:95], v[184:187], v[208:211], v[92:95]
    ds_read_b64_tr_b16 v[156:157], v12 offset:49152
    v_mfma_f32_16x16x32_bf16 v[96:99], v[188:191], v[208:211], v[96:99]
    ds_read_b64_tr_b16 v[158:159], v12 offset:49664
    v_mfma_f32_16x16x32_bf16 v[100:103], v[192:195], v[208:211], v[100:103]
    buffer_load_dwordx4 v6, s[40:43], s74 offen offset:1024 lds
    v_mfma_f32_16x16x32_bf16 v[104:107], v[196:199], v[208:211], v[104:107]
    ds_read_b128 v[164:167], v13 offset:34816
    v_mfma_f32_16x16x32_bf16 v[108:111], v[176:179], v[212:215], v[108:111]
    ds_read_b128 v[168:171], v13 offset:36864
    s_add_u32 m0, s76, 40960
    v_mfma_f32_16x16x32_bf16 v[112:115], v[180:183], v[212:215], v[112:115]
    ds_read_b128 v[172:175], v13 offset:38912
    s_mov_b32 s74, 1548544
    v_mfma_f32_16x16x32_bf16 v[116:119], v[184:187], v[212:215], v[116:119]
    buffer_load_dwordx4 v5, s[40:43], s74 offen offset:0 lds
    v_mfma_f32_16x16x32_bf16 v[120:123], v[188:191], v[212:215], v[120:123]
    v_mfma_f32_16x16x32_bf16 v[124:127], v[192:195], v[212:215], v[124:127]
    v_mfma_f32_16x16x32_bf16 v[128:131], v[196:199], v[212:215], v[128:131]
    s_waitcnt lgkmcnt(0)
    v_mfma_f32_16x16x32_bf16 v[36:39], v[136:139], v[160:163], v[36:39]
    ds_read_b128 v[200:203], v134 offset:32768
    v_mfma_f32_16x16x32_bf16 v[40:43], v[140:143], v[160:163], v[40:43]
    buffer_load_dwordx4 v6, s[40:43], s74 offen offset:1024 lds
    v_mfma_f32_16x16x32_bf16 v[44:47], v[144:147], v[160:163], v[44:47]
    ds_read_b64_tr_b16 v[176:177], v7 offset:53248
    v_mfma_f32_16x16x32_bf16 v[48:51], v[148:151], v[160:163], v[48:51]
    ds_read_b64_tr_b16 v[178:179], v7 offset:53760
    v_mfma_f32_16x16x32_bf16 v[52:55], v[152:155], v[160:163], v[52:55]
    ds_read_b64_tr_b16 v[180:181], v8 offset:53248
    s_add_u32 m0, s75, 16384
    v_mfma_f32_16x16x32_bf16 v[56:59], v[156:159], v[160:163], v[56:59]
    ds_read_b64_tr_b16 v[182:183], v8 offset:53760
    s_movk_i32 s73, 896
    v_mfma_f32_16x16x32_bf16 v[60:63], v[136:139], v[164:167], v[60:63]
    buffer_load_dwordx4 v1, s[28:31], s73 offen offset:0 lds
    v_mfma_f32_16x16x32_bf16 v[64:67], v[140:143], v[164:167], v[64:67]
    ds_read_b64_tr_b16 v[184:185], v9 offset:53248
    v_mfma_f32_16x16x32_bf16 v[68:71], v[144:147], v[164:167], v[68:71]
    ds_read_b64_tr_b16 v[186:187], v9 offset:53760
    v_mfma_f32_16x16x32_bf16 v[72:75], v[148:151], v[164:167], v[72:75]
    ds_read_b64_tr_b16 v[188:189], v10 offset:53248
    v_mfma_f32_16x16x32_bf16 v[76:79], v[152:155], v[164:167], v[76:79]
    ds_read_b64_tr_b16 v[190:191], v10 offset:53760
    v_mfma_f32_16x16x32_bf16 v[80:83], v[156:159], v[164:167], v[80:83]
    buffer_load_dwordx4 v2, s[28:31], s73 offen offset:1024 lds
    v_mfma_f32_16x16x32_bf16 v[84:87], v[136:139], v[168:171], v[84:87]
    ds_read_b64_tr_b16 v[192:193], v11 offset:53248
    v_mfma_f32_16x16x32_bf16 v[88:91], v[140:143], v[168:171], v[88:91]
    ds_read_b64_tr_b16 v[194:195], v11 offset:53760
    v_mfma_f32_16x16x32_bf16 v[92:95], v[144:147], v[168:171], v[92:95]
    ds_read_b64_tr_b16 v[196:197], v12 offset:53248
    v_mfma_f32_16x16x32_bf16 v[96:99], v[148:151], v[168:171], v[96:99]
    ds_read_b64_tr_b16 v[198:199], v12 offset:53760
    v_mfma_f32_16x16x32_bf16 v[100:103], v[152:155], v[168:171], v[100:103]
    buffer_load_dwordx4 v3, s[28:31], s73 offen offset:2048 lds
    v_mfma_f32_16x16x32_bf16 v[104:107], v[156:159], v[168:171], v[104:107]
    ds_read_b128 v[204:207], v134 offset:34816
    v_mfma_f32_16x16x32_bf16 v[108:111], v[136:139], v[172:175], v[108:111]
    ds_read_b128 v[208:211], v134 offset:36864
    v_mfma_f32_16x16x32_bf16 v[112:115], v[140:143], v[172:175], v[112:115]
    ds_read_b128 v[212:215], v134 offset:38912
    v_mfma_f32_16x16x32_bf16 v[116:119], v[144:147], v[172:175], v[116:119]
    buffer_load_dwordx4 v4, s[28:31], s73 offen offset:3072 lds
    v_mfma_f32_16x16x32_bf16 v[120:123], v[148:151], v[172:175], v[120:123]
    v_mfma_f32_16x16x32_bf16 v[124:127], v[152:155], v[172:175], v[124:127]
    v_mfma_f32_16x16x32_bf16 v[128:131], v[156:159], v[172:175], v[128:131]
    s_waitcnt vmcnt(10) lgkmcnt(0)
    s_barrier
    v_mfma_f32_16x16x32_bf16 v[36:39], v[176:179], v[200:203], v[36:39]
    ds_read_b128 v[160:163], v13 offset:0
    s_add_u32 m0, s76, 49152
    s_mov_b32 s74, 1769472
    v_mfma_f32_16x16x32_bf16 v[40:43], v[180:183], v[200:203], v[40:43]
    buffer_load_dwordx4 v5, s[40:43], s74 offen offset:0 lds
    v_mfma_f32_16x16x32_bf16 v[44:47], v[184:187], v[200:203], v[44:47]
    ds_read_b64_tr_b16 v[136:137], v7 offset:0
    v_mfma_f32_16x16x32_bf16 v[48:51], v[188:191], v[200:203], v[48:51]
    ds_read_b64_tr_b16 v[138:139], v7 offset:512
    v_mfma_f32_16x16x32_bf16 v[52:55], v[192:195], v[200:203], v[52:55]
    ds_read_b64_tr_b16 v[140:141], v8 offset:0
    v_mfma_f32_16x16x32_bf16 v[56:59], v[196:199], v[200:203], v[56:59]
    ds_read_b64_tr_b16 v[142:143], v8 offset:512
    v_mfma_f32_16x16x32_bf16 v[60:63], v[176:179], v[204:207], v[60:63]
    buffer_load_dwordx4 v6, s[40:43], s74 offen offset:1024 lds
    v_mfma_f32_16x16x32_bf16 v[64:67], v[180:183], v[204:207], v[64:67]
    ds_read_b64_tr_b16 v[144:145], v9 offset:0
    v_mfma_f32_16x16x32_bf16 v[68:71], v[184:187], v[204:207], v[68:71]
    ds_read_b64_tr_b16 v[146:147], v9 offset:512
    v_mfma_f32_16x16x32_bf16 v[72:75], v[188:191], v[204:207], v[72:75]
    ds_read_b64_tr_b16 v[148:149], v10 offset:0
    s_add_u32 m0, s76, 57344
    v_mfma_f32_16x16x32_bf16 v[76:79], v[192:195], v[204:207], v[76:79]
    ds_read_b64_tr_b16 v[150:151], v10 offset:512
    s_mov_b32 s74, 1769600
    v_mfma_f32_16x16x32_bf16 v[80:83], v[196:199], v[204:207], v[80:83]
    buffer_load_dwordx4 v5, s[40:43], s74 offen offset:0 lds
    v_mfma_f32_16x16x32_bf16 v[84:87], v[176:179], v[208:211], v[84:87]
    ds_read_b64_tr_b16 v[152:153], v11 offset:0
    v_mfma_f32_16x16x32_bf16 v[88:91], v[180:183], v[208:211], v[88:91]
    ds_read_b64_tr_b16 v[154:155], v11 offset:512
    v_mfma_f32_16x16x32_bf16 v[92:95], v[184:187], v[208:211], v[92:95]
    ds_read_b64_tr_b16 v[156:157], v12 offset:0
    v_mfma_f32_16x16x32_bf16 v[96:99], v[188:191], v[208:211], v[96:99]
    ds_read_b64_tr_b16 v[158:159], v12 offset:512
    v_mfma_f32_16x16x32_bf16 v[100:103], v[192:195], v[208:211], v[100:103]
    buffer_load_dwordx4 v6, s[40:43], s74 offen offset:1024 lds
    v_mfma_f32_16x16x32_bf16 v[104:107], v[196:199], v[208:211], v[104:107]
    ds_read_b128 v[164:167], v13 offset:2048
    v_mfma_f32_16x16x32_bf16 v[108:111], v[176:179], v[212:215], v[108:111]
    ds_read_b128 v[168:171], v13 offset:4096
    s_add_u32 m0, s76, 65536
    v_mfma_f32_16x16x32_bf16 v[112:115], v[180:183], v[212:215], v[112:115]
    ds_read_b128 v[172:175], v13 offset:6144
    s_mov_b32 s74, 1769728
    v_mfma_f32_16x16x32_bf16 v[116:119], v[184:187], v[212:215], v[116:119]
    buffer_load_dwordx4 v5, s[40:43], s74 offen offset:0 lds
    v_mfma_f32_16x16x32_bf16 v[120:123], v[188:191], v[212:215], v[120:123]
    v_mfma_f32_16x16x32_bf16 v[124:127], v[192:195], v[212:215], v[124:127]
    v_mfma_f32_16x16x32_bf16 v[128:131], v[196:199], v[212:215], v[128:131]
    s_waitcnt lgkmcnt(0)
    v_mfma_f32_16x16x32_bf16 v[36:39], v[136:139], v[160:163], v[36:39]
    ds_read_b128 v[200:203], v134 offset:0
    v_mfma_f32_16x16x32_bf16 v[40:43], v[140:143], v[160:163], v[40:43]
    buffer_load_dwordx4 v6, s[40:43], s74 offen offset:1024 lds
    v_mfma_f32_16x16x32_bf16 v[44:47], v[144:147], v[160:163], v[44:47]
    ds_read_b64_tr_b16 v[176:177], v7 offset:4096
    v_mfma_f32_16x16x32_bf16 v[48:51], v[148:151], v[160:163], v[48:51]
    ds_read_b64_tr_b16 v[178:179], v7 offset:4608
    v_mfma_f32_16x16x32_bf16 v[52:55], v[152:155], v[160:163], v[52:55]
    ds_read_b64_tr_b16 v[180:181], v8 offset:4096
    s_add_u32 m0, s75, 32768
    v_mfma_f32_16x16x32_bf16 v[56:59], v[156:159], v[160:163], v[56:59]
    ds_read_b64_tr_b16 v[182:183], v8 offset:4608
    s_movk_i32 s73, 1024
    v_mfma_f32_16x16x32_bf16 v[60:63], v[136:139], v[164:167], v[60:63]
    buffer_load_dwordx4 v1, s[28:31], s73 offen offset:0 lds
    v_mfma_f32_16x16x32_bf16 v[64:67], v[140:143], v[164:167], v[64:67]
    ds_read_b64_tr_b16 v[184:185], v9 offset:4096
    v_mfma_f32_16x16x32_bf16 v[68:71], v[144:147], v[164:167], v[68:71]
    ds_read_b64_tr_b16 v[186:187], v9 offset:4608
    v_mfma_f32_16x16x32_bf16 v[72:75], v[148:151], v[164:167], v[72:75]
    ds_read_b64_tr_b16 v[188:189], v10 offset:4096
    v_mfma_f32_16x16x32_bf16 v[76:79], v[152:155], v[164:167], v[76:79]
    ds_read_b64_tr_b16 v[190:191], v10 offset:4608
    v_mfma_f32_16x16x32_bf16 v[80:83], v[156:159], v[164:167], v[80:83]
    buffer_load_dwordx4 v2, s[28:31], s73 offen offset:1024 lds
    v_mfma_f32_16x16x32_bf16 v[84:87], v[136:139], v[168:171], v[84:87]
    ds_read_b64_tr_b16 v[192:193], v11 offset:4096
    v_mfma_f32_16x16x32_bf16 v[88:91], v[140:143], v[168:171], v[88:91]
    ds_read_b64_tr_b16 v[194:195], v11 offset:4608
    v_mfma_f32_16x16x32_bf16 v[92:95], v[144:147], v[168:171], v[92:95]
    ds_read_b64_tr_b16 v[196:197], v12 offset:4096
    v_mfma_f32_16x16x32_bf16 v[96:99], v[148:151], v[168:171], v[96:99]
    ds_read_b64_tr_b16 v[198:199], v12 offset:4608
    v_mfma_f32_16x16x32_bf16 v[100:103], v[152:155], v[168:171], v[100:103]
    buffer_load_dwordx4 v3, s[28:31], s73 offen offset:2048 lds
    v_mfma_f32_16x16x32_bf16 v[104:107], v[156:159], v[168:171], v[104:107]
    ds_read_b128 v[204:207], v134 offset:2048
    v_mfma_f32_16x16x32_bf16 v[108:111], v[136:139], v[172:175], v[108:111]
    ds_read_b128 v[208:211], v134 offset:4096
    v_mfma_f32_16x16x32_bf16 v[112:115], v[140:143], v[172:175], v[112:115]
    ds_read_b128 v[212:215], v134 offset:6144
    v_mfma_f32_16x16x32_bf16 v[116:119], v[144:147], v[172:175], v[116:119]
    buffer_load_dwordx4 v4, s[28:31], s73 offen offset:3072 lds
    v_mfma_f32_16x16x32_bf16 v[120:123], v[148:151], v[172:175], v[120:123]
    v_mfma_f32_16x16x32_bf16 v[124:127], v[152:155], v[172:175], v[124:127]
    v_mfma_f32_16x16x32_bf16 v[128:131], v[156:159], v[172:175], v[128:131]
    s_waitcnt vmcnt(10) lgkmcnt(0)
    s_barrier
    v_mfma_f32_16x16x32_bf16 v[36:39], v[176:179], v[200:203], v[36:39]
    ds_read_b128 v[160:163], v13 offset:16384
    s_mul_i32 s4, s64, 1792
    s_add_u32 s4, s4, 49152
    v_min_u32 v255, 27, v0
    v_mfma_f32_16x16x32_bf16 v[40:43], v[180:183], v[200:203], v[40:43]
    ds_read_b64_tr_b16 v[136:137], v7 offset:24576
    v_lshl_add_u32 v255, v255, 6, s4
    buffer_load_dword v252, v255, s[56:59], 0 offen sc1
    v_mfma_f32_16x16x32_bf16 v[44:47], v[184:187], v[200:203], v[44:47]
    ds_read_b64_tr_b16 v[138:139], v7 offset:25088
    v_mfma_f32_16x16x32_bf16 v[48:51], v[188:191], v[200:203], v[48:51]
    s_add_u32 m0, s76, 0
    v_mfma_f32_16x16x32_bf16 v[52:55], v[192:195], v[200:203], v[52:55]
    ds_read_b64_tr_b16 v[140:141], v8 offset:24576
    s_mov_b32 s74, 1990656
    v_mfma_f32_16x16x32_bf16 v[56:59], v[196:199], v[200:203], v[56:59]
    ds_read_b64_tr_b16 v[142:143], v8 offset:25088
    buffer_load_dwordx4 v5, s[40:43], s74 offen offset:0 lds
    v_mfma_f32_16x16x32_bf16 v[60:63], v[176:179], v[204:207], v[60:63]
    ds_read_b64_tr_b16 v[144:145], v9 offset:24576
    v_mfma_f32_16x16x32_bf16 v[64:67], v[180:183], v[204:207], v[64:67]
    v_mfma_f32_16x16x32_bf16 v[68:71], v[184:187], v[204:207], v[68:71]
    ds_read_b64_tr_b16 v[146:147], v9 offset:25088
    v_mfma_f32_16x16x32_bf16 v[72:75], v[188:191], v[204:207], v[72:75]
    ds_read_b64_tr_b16 v[148:149], v10 offset:24576
    buffer_load_dwordx4 v6, s[40:43], s74 offen offset:1024 lds
    v_mfma_f32_16x16x32_bf16 v[76:79], v[192:195], v[204:207], v[76:79]
    v_mfma_f32_16x16x32_bf16 v[80:83], v[196:199], v[204:207], v[80:83]
    ds_read_b64_tr_b16 v[150:151], v10 offset:25088
    s_add_u32 m0, s76, 8192
    v_mfma_f32_16x16x32_bf16 v[84:87], v[176:179], v[208:211], v[84:87]
    ds_read_b64_tr_b16 v[152:153], v11 offset:24576
    s_mov_b32 s74, 1990784
    v_mfma_f32_16x16x32_bf16 v[88:91], v[180:183], v[208:211], v[88:91]
    ds_read_b64_tr_b16 v[154:155], v11 offset:25088
    buffer_load_dwordx4 v5, s[40:43], s74 offen offset:0 lds
    v_mfma_f32_16x16x32_bf16 v[92:95], v[184:187], v[208:211], v[92:95]
    v_mfma_f32_16x16x32_bf16 v[96:99], v[188:191], v[208:211], v[96:99]
    ds_read_b64_tr_b16 v[156:157], v12 offset:24576
    v_mfma_f32_16x16x32_bf16 v[100:103], v[192:195], v[208:211], v[100:103]
    ds_read_b64_tr_b16 v[158:159], v12 offset:25088
    v_mfma_f32_16x16x32_bf16 v[104:107], v[196:199], v[208:211], v[104:107]
    ds_read_b128 v[164:167], v13 offset:18432
    buffer_load_dwordx4 v6, s[40:43], s74 offen offset:1024 lds
    v_mfma_f32_16x16x32_bf16 v[108:111], v[176:179], v[212:215], v[108:111]
    v_mfma_f32_16x16x32_bf16 v[112:115], v[180:183], v[212:215], v[112:115]
    ds_read_b128 v[168:171], v13 offset:20480
    s_add_u32 m0, s76, 16384
    v_mfma_f32_16x16x32_bf16 v[116:119], v[184:187], v[212:215], v[116:119]
    ds_read_b128 v[172:175], v13 offset:22528
    s_mov_b32 s74, 1990912
    v_mfma_f32_16x16x32_bf16 v[120:123], v[188:191], v[212:215], v[120:123]
    buffer_load_dwordx4 v5, s[40:43], s74 offen offset:0 lds
    v_mfma_f32_16x16x32_bf16 v[124:127], v[192:195], v[212:215], v[124:127]
    v_mfma_f32_16x16x32_bf16 v[128:131], v[196:199], v[212:215], v[128:131]
    s_waitcnt lgkmcnt(0)
    v_mfma_f32_16x16x32_bf16 v[36:39], v[136:139], v[160:163], v[36:39]
    ds_read_b128 v[200:203], v134 offset:16384
    v_mfma_f32_16x16x32_bf16 v[40:43], v[140:143], v[160:163], v[40:43]
    buffer_load_dwordx4 v6, s[40:43], s74 offen offset:1024 lds
    v_mfma_f32_16x16x32_bf16 v[44:47], v[144:147], v[160:163], v[44:47]
    ds_read_b64_tr_b16 v[176:177], v7 offset:28672
    v_mfma_f32_16x16x32_bf16 v[48:51], v[148:151], v[160:163], v[48:51]
    ds_read_b64_tr_b16 v[178:179], v7 offset:29184
    v_mfma_f32_16x16x32_bf16 v[52:55], v[152:155], v[160:163], v[52:55]
    ds_read_b64_tr_b16 v[180:181], v8 offset:28672
    s_add_u32 m0, s75, 0
    v_mfma_f32_16x16x32_bf16 v[56:59], v[156:159], v[160:163], v[56:59]
    ds_read_b64_tr_b16 v[182:183], v8 offset:29184
    s_movk_i32 s73, 1152
    v_mfma_f32_16x16x32_bf16 v[60:63], v[136:139], v[164:167], v[60:63]
    buffer_load_dwordx4 v1, s[28:31], s73 offen offset:0 lds
    v_mfma_f32_16x16x32_bf16 v[64:67], v[140:143], v[164:167], v[64:67]
    ds_read_b64_tr_b16 v[184:185], v9 offset:28672
    v_mfma_f32_16x16x32_bf16 v[68:71], v[144:147], v[164:167], v[68:71]
    ds_read_b64_tr_b16 v[186:187], v9 offset:29184
    v_mfma_f32_16x16x32_bf16 v[72:75], v[148:151], v[164:167], v[72:75]
    ds_read_b64_tr_b16 v[188:189], v10 offset:28672
    v_mfma_f32_16x16x32_bf16 v[76:79], v[152:155], v[164:167], v[76:79]
    ds_read_b64_tr_b16 v[190:191], v10 offset:29184
    v_mfma_f32_16x16x32_bf16 v[80:83], v[156:159], v[164:167], v[80:83]
    buffer_load_dwordx4 v2, s[28:31], s73 offen offset:1024 lds
    v_mfma_f32_16x16x32_bf16 v[84:87], v[136:139], v[168:171], v[84:87]
    ds_read_b64_tr_b16 v[192:193], v11 offset:28672
    v_mfma_f32_16x16x32_bf16 v[88:91], v[140:143], v[168:171], v[88:91]
    ds_read_b64_tr_b16 v[194:195], v11 offset:29184
    v_mfma_f32_16x16x32_bf16 v[92:95], v[144:147], v[168:171], v[92:95]
    ds_read_b64_tr_b16 v[196:197], v12 offset:28672
    v_mfma_f32_16x16x32_bf16 v[96:99], v[148:151], v[168:171], v[96:99]
    ds_read_b64_tr_b16 v[198:199], v12 offset:29184
    v_mfma_f32_16x16x32_bf16 v[100:103], v[152:155], v[168:171], v[100:103]
    buffer_load_dwordx4 v3, s[28:31], s73 offen offset:2048 lds
    v_mfma_f32_16x16x32_bf16 v[104:107], v[156:159], v[168:171], v[104:107]
    ds_read_b128 v[204:207], v134 offset:18432
    v_mfma_f32_16x16x32_bf16 v[108:111], v[136:139], v[172:175], v[108:111]
    ds_read_b128 v[208:211], v134 offset:20480
    v_mfma_f32_16x16x32_bf16 v[112:115], v[140:143], v[172:175], v[112:115]
    ds_read_b128 v[212:215], v134 offset:22528
    v_mfma_f32_16x16x32_bf16 v[116:119], v[144:147], v[172:175], v[116:119]
    buffer_load_dwordx4 v4, s[28:31], s73 offen offset:3072 lds
    v_mfma_f32_16x16x32_bf16 v[120:123], v[148:151], v[172:175], v[120:123]
    v_mfma_f32_16x16x32_bf16 v[124:127], v[152:155], v[172:175], v[124:127]
    v_mfma_f32_16x16x32_bf16 v[128:131], v[156:159], v[172:175], v[128:131]
    s_waitcnt vmcnt(10)
    v_cmp_ne_u32 vcc, s65, v252
    s_cbranch_vccnz L_spin1
L_ok2:
    s_waitcnt lgkmcnt(0)
    s_barrier
    v_mfma_f32_16x16x32_bf16 v[36:39], v[176:179], v[200:203], v[36:39]
    ds_read_b128 v[160:163], v13 offset:32768
    v_lshlrev_b32 v253, 2, v0
    v_mfma_f32_16x16x32_bf16 v[40:43], v[180:183], v[200:203], v[40:43]
    ds_read_b64_tr_b16 v[136:137], v7 offset:49152
    buffer_load_dword v252, v253, s[56:59], s91 offen sc1
    v_mfma_f32_16x16x32_bf16 v[44:47], v[184:187], v[200:203], v[44:47]
    ds_read_b64_tr_b16 v[138:139], v7 offset:49664
    s_mul_i32 s4, s64, 256
    s_add_u32 s4, s4, 161280
    v_add_u32 v254, s4, v253
    v_mfma_f32_16x16x32_bf16 v[48:51], v[188:191], v[200:203], v[48:51]
    s_mul_i32 s4, s71, 768
    s_mul_i32 s7, s64, 192
    s_add_u32 s4, s4, s7
    v_mfma_f32_16x16x32_bf16 v[52:55], v[192:195], v[200:203], v[52:55]
    ds_read_b64_tr_b16 v[140:141], v8 offset:49152
    s_add_u32 s4, s4, 163840
    v_min_u32 v33, 47, v0
    v_lshlrev_b32 v33, 2, v33
    v_mfma_f32_16x16x32_bf16 v[56:59], v[196:199], v[200:203], v[56:59]
    ds_read_b64_tr_b16 v[142:143], v8 offset:49664
    buffer_load_dword v216, v33, s[56:59], s4 offen sc1
    v_mfma_f32_16x16x32_bf16 v[60:63], v[176:179], v[204:207], v[60:63]
    ds_read_b64_tr_b16 v[144:145], v9 offset:49152
    s_add_u32 s4, s4, 7168
    v_mfma_f32_16x16x32_bf16 v[64:67], v[180:183], v[204:207], v[64:67]
    buffer_load_dword v217, v33, s[56:59], s4 offen sc1
    v_mfma_f32_16x16x32_bf16 v[68:71], v[184:187], v[204:207], v[68:71]
    ds_read_b64_tr_b16 v[146:147], v9 offset:49664
    v_mfma_f32_16x16x32_bf16 v[72:75], v[188:191], v[204:207], v[72:75]
    ds_read_b64_tr_b16 v[148:149], v10 offset:49152
    s_add_u32 s4, s4, 7168
    v_mfma_f32_16x16x32_bf16 v[76:79], v[192:195], v[204:207], v[76:79]
    buffer_load_dword v218, v33, s[56:59], s4 offen sc1
    v_mfma_f32_16x16x32_bf16 v[80:83], v[196:199], v[204:207], v[80:83]
    ds_read_b64_tr_b16 v[150:151], v10 offset:49664
    v_mfma_f32_16x16x32_bf16 v[84:87], v[176:179], v[208:211], v[84:87]
    ds_read_b64_tr_b16 v[152:153], v11 offset:49152
    s_add_u32 s4, s4, 7168
    v_mfma_f32_16x16x32_bf16 v[88:91], v[180:183], v[208:211], v[88:91]
    ds_read_b64_tr_b16 v[154:155], v11 offset:49664
    buffer_load_dword v219, v33, s[56:59], s4 offen sc1
    v_mfma_f32_16x16x32_bf16 v[92:95], v[184:187], v[208:211], v[92:95]
    s_mul_i32 s4, s64, 192
    s_add_u32 s4, s4, 162304
    v_mfma_f32_16x16x32_bf16 v[96:99], v[188:191], v[208:211], v[96:99]
    ds_read_b64_tr_b16 v[156:157], v12 offset:49152
    v_add_u32 v33, s4, v33
    v_mfma_f32_16x16x32_bf16 v[100:103], v[192:195], v[208:211], v[100:103]
    ds_read_b64_tr_b16 v[158:159], v12 offset:49664
    buffer_load_dwordx4 a[0:3], v14, s[56:59], s23 offen offset:0 sc1
    v_mfma_f32_16x16x32_bf16 v[104:107], v[196:199], v[208:211], v[104:107]
    ds_read_b128 v[164:167], v13 offset:34816
    v_mfma_f32_16x16x32_bf16 v[108:111], v[176:179], v[212:215], v[108:111]
    v_mfma_f32_16x16x32_bf16 v[112:115], v[180:183], v[212:215], v[112:115]
    ds_read_b128 v[168:171], v13 offset:36864
    buffer_load_dwordx4 a[4:7], v14, s[56:59], s23 offen offset:1024 sc1
    v_mfma_f32_16x16x32_bf16 v[116:119], v[184:187], v[212:215], v[116:119]
    ds_read_b128 v[172:175], v13 offset:38912
    v_mfma_f32_16x16x32_bf16 v[120:123], v[188:191], v[212:215], v[120:123]
    v_mfma_f32_16x16x32_bf16 v[124:127], v[192:195], v[212:215], v[124:127]
    buffer_load_dwordx4 a[8:11], v14, s[56:59], s23 offen offset:2048 sc1
    v_mfma_f32_16x16x32_bf16 v[128:131], v[196:199], v[212:215], v[128:131]
    s_waitcnt lgkmcnt(0)
    v_mfma_f32_16x16x32_bf16 v[36:39], v[136:139], v[160:163], v[36:39]
    ds_read_b128 v[200:203], v134 offset:32768
    v_mfma_f32_16x16x32_bf16 v[40:43], v[140:143], v[160:163], v[40:43]
    buffer_load_dwordx4 a[12:15], v14, s[56:59], s23 offen offset:3072 sc1
    v_mfma_f32_16x16x32_bf16 v[44:47], v[144:147], v[160:163], v[44:47]
    ds_read_b64_tr_b16 v[176:177], v7 offset:53248
    v_mfma_f32_16x16x32_bf16 v[48:51], v[148:151], v[160:163], v[48:51]
    ds_read_b64_tr_b16 v[178:179], v7 offset:53760
    v_mfma_f32_16x16x32_bf16 v[52:55], v[152:155], v[160:163], v[52:55]
    ds_read_b64_tr_b16 v[180:181], v8 offset:53248
    s_add_u32 s23, s23, 4096
    v_mfma_f32_16x16x32_bf16 v[56:59], v[156:159], v[160:163], v[56:59]
    buffer_load_dwordx4 a[16:19], v14, s[56:59], s23 offen offset:0 sc1
    v_mfma_f32_16x16x32_bf16 v[60:63], v[136:139], v[164:167], v[60:63]
    ds_read_b64_tr_b16 v[182:183], v8 offset:53760
    v_mfma_f32_16x16x32_bf16 v[64:67], v[140:143], v[164:167], v[64:67]
    ds_read_b64_tr_b16 v[184:185], v9 offset:53248
    v_mfma_f32_16x16x32_bf16 v[68:71], v[144:147], v[164:167], v[68:71]
    ds_read_b64_tr_b16 v[186:187], v9 offset:53760
    v_mfma_f32_16x16x32_bf16 v[72:75], v[148:151], v[164:167], v[72:75]
    buffer_load_dwordx4 a[20:23], v14, s[56:59], s23 offen offset:1024 sc1
    v_mfma_f32_16x16x32_bf16 v[76:79], v[152:155], v[164:167], v[76:79]
    ds_read_b64_tr_b16 v[188:189], v10 offset:53248
    v_mfma_f32_16x16x32_bf16 v[80:83], v[156:159], v[164:167], v[80:83]
    ds_read_b64_tr_b16 v[190:191], v10 offset:53760
    v_mfma_f32_16x16x32_bf16 v[84:87], v[136:139], v[168:171], v[84:87]
    ds_read_b64_tr_b16 v[192:193], v11 offset:53248
    v_mfma_f32_16x16x32_bf16 v[88:91], v[140:143], v[168:171], v[88:91]
    buffer_load_dwordx4 a[24:27], v14, s[56:59], s23 offen offset:2048 sc1
    v_mfma_f32_16x16x32_bf16 v[92:95], v[144:147], v[168:171], v[92:95]
    ds_read_b64_tr_b16 v[194:195], v11 offset:53760
    v_mfma_f32_16x16x32_bf16 v[96:99], v[148:151], v[168:171], v[96:99]
    ds_read_b64_tr_b16 v[196:197], v12 offset:53248
    v_mfma_f32_16x16x32_bf16 v[100:103], v[152:155], v[168:171], v[100:103]
    ds_read_b64_tr_b16 v[198:199], v12 offset:53760
    v_mfma_f32_16x16x32_bf16 v[104:107], v[156:159], v[168:171], v[104:107]
    buffer_load_dwordx4 a[28:31], v14, s[56:59], s23 offen offset:3072 sc1
    v_mfma_f32_16x16x32_bf16 v[108:111], v[136:139], v[172:175], v[108:111]
    ds_read_b128 v[204:207], v134 offset:34816
    v_mfma_f32_16x16x32_bf16 v[112:115], v[140:143], v[172:175], v[112:115]
    ds_read_b128 v[208:211], v134 offset:36864
    v_mfma_f32_16x16x32_bf16 v[116:119], v[144:147], v[172:175], v[116:119]
    ds_read_b128 v[212:215], v134 offset:38912
    s_add_u32 s23, s23, 4096
    v_mfma_f32_16x16x32_bf16 v[120:123], v[148:151], v[172:175], v[120:123]
    buffer_load_dwordx4 a[32:35], v14, s[56:59], s23 offen offset:0 sc1
    v_mfma_f32_16x16x32_bf16 v[124:127], v[152:155], v[172:175], v[124:127]
    v_mfma_f32_16x16x32_bf16 v[128:131], v[156:159], v[172:175], v[128:131]
    s_waitcnt vmcnt(13)
    v_cmp_ne_u32 vcc, s65, v252
    s_and_b32 vcc_lo, vcc_lo, 0xff00ff00
    s_and_b32 vcc_hi, vcc_hi, 0xff00ff00
    s_or_b64 vcc, vcc, 0
    s_cbranch_vccnz L_spin3
L_ok4:
    ds_write_b32 v254, v252
    s_waitcnt vmcnt(9)
    v_add_f32 v216, v216, v217
    v_add_f32 v216, v216, v218
    v_add_f32 v216, v216, v219
    ds_write_b32 v33, v216
    s_waitcnt lgkmcnt(0)
    s_barrier
    v_mfma_f32_16x16x32_bf16 v[36:39], v[176:179], v[200:203], v[36:39]
    ds_read_b128 v[160:163], v13 offset:0
    s_and_b32 s5, s64, 1
    v_mfma_f32_16x16x32_bf16 v[40:43], v[180:183], v[200:203], v[40:43]
    ds_read_b64_tr_b16 v[136:137], v7 offset:0
    buffer_load_dwordx4 a[36:39], v14, s[56:59], s23 offen offset:1024 sc1
    v_mfma_f32_16x16x32_bf16 v[44:47], v[184:187], v[200:203], v[44:47]
    ds_read_b64_tr_b16 v[138:139], v7 offset:512
    v_mfma_f32_16x16x32_bf16 v[48:51], v[188:191], v[200:203], v[48:51]
    v_mfma_f32_16x16x32_bf16 v[52:55], v[192:195], v[200:203], v[52:55]
    ds_read_b64_tr_b16 v[140:141], v8 offset:0
    s_mul_i32 s5, s5, 16
    v_mfma_f32_16x16x32_bf16 v[56:59], v[196:199], v[200:203], v[56:59]
    ds_read_b64_tr_b16 v[142:143], v8 offset:512
    buffer_load_dwordx4 a[40:43], v14, s[56:59], s23 offen offset:2048 sc1
    v_mfma_f32_16x16x32_bf16 v[60:63], v[176:179], v[204:207], v[60:63]
    ds_read_b64_tr_b16 v[144:145], v9 offset:0
    v_mfma_f32_16x16x32_bf16 v[64:67], v[180:183], v[204:207], v[64:67]
    v_mfma_f32_16x16x32_bf16 v[68:71], v[184:187], v[204:207], v[68:71]
    ds_read_b64_tr_b16 v[146:147], v9 offset:512
    v_mfma_f32_16x16x32_bf16 v[72:75], v[188:191], v[204:207], v[72:75]
    ds_read_b64_tr_b16 v[148:149], v10 offset:0
    s_add_u32 s5, s5, 161280
    buffer_load_dwordx4 a[44:47], v14, s[56:59], s23 offen offset:3072 sc1
    v_mfma_f32_16x16x32_bf16 v[76:79], v[192:195], v[204:207], v[76:79]
    v_mfma_f32_16x16x32_bf16 v[80:83], v[196:199], v[204:207], v[80:83]
    ds_read_b64_tr_b16 v[150:151], v10 offset:512
    v_mfma_f32_16x16x32_bf16 v[84:87], v[176:179], v[208:211], v[84:87]
    ds_read_b64_tr_b16 v[152:153], v11 offset:0
    s_add_u32 s23, s23, 4096
    v_mfma_f32_16x16x32_bf16 v[88:91], v[180:183], v[208:211], v[88:91]
    ds_read_b64_tr_b16 v[154:155], v11 offset:512
    buffer_load_dwordx4 a[48:51], v14, s[56:59], s23 offen offset:0 sc1
    v_mfma_f32_16x16x32_bf16 v[92:95], v[184:187], v[208:211], v[92:95]
    v_add_u32 v35, s5, v28
    v_mfma_f32_16x16x32_bf16 v[96:99], v[188:191], v[208:211], v[96:99]
    ds_read_b64_tr_b16 v[156:157], v12 offset:0
    v_mfma_f32_16x16x32_bf16 v[100:103], v[192:195], v[208:211], v[100:103]
    ds_read_b64_tr_b16 v[158:159], v12 offset:512
    v_mfma_f32_16x16x32_bf16 v[104:107], v[196:199], v[208:211], v[104:107]
    ds_read_b128 v[164:167], v13 offset:2048
    buffer_load_dwordx4 a[52:55], v14, s[56:59], s23 offen offset:1024 sc1
    v_mfma_f32_16x16x32_bf16 v[108:111], v[176:179], v[212:215], v[108:111]
    v_mfma_f32_16x16x32_bf16 v[112:115], v[180:183], v[212:215], v[112:115]
    ds_read_b128 v[168:171], v13 offset:4096
    ds_read_b128 v[240:243], v35
    v_mfma_f32_16x16x32_bf16 v[116:119], v[184:187], v[212:215], v[116:119]
    ds_read_b128 v[172:175], v13 offset:6144
    v_mfma_f32_16x16x32_bf16 v[120:123], v[188:191], v[212:215], v[120:123]
    buffer_load_dwordx4 a[56:59], v14, s[56:59], s23 offen offset:2048 sc1
    v_mfma_f32_16x16x32_bf16 v[124:127], v[192:195], v[212:215], v[124:127]
    v_mfma_f32_16x16x32_bf16 v[128:131], v[196:199], v[212:215], v[128:131]
    s_waitcnt lgkmcnt(0)
    v_mfma_f32_16x16x32_bf16 v[36:39], v[136:139], v[160:163], v[36:39]
    ds_read_b128 v[200:203], v134 offset:0
    v_and_b32 v244, 0xffff0000, v240
    v_mfma_f32_16x16x32_bf16 v[40:43], v[140:143], v[160:163], v[40:43]
    ds_read_b64_tr_b16 v[176:177], v7 offset:4096
    v_and_b32 v246, 0xffff0000, v241
    buffer_load_dwordx4 a[60:63], v14, s[56:59], s23 offen offset:3072 sc1
    v_mfma_f32_16x16x32_bf16 v[44:47], v[144:147], v[160:163], v[44:47]
    ds_read_b64_tr_b16 v[178:179], v7 offset:4608
    v_and_b32 v248, 0xffff0000, v242
    v_mfma_f32_16x16x32_bf16 v[48:51], v[148:151], v[160:163], v[48:51]
    v_and_b32 v250, 0xffff0000, v243
    v_mfma_f32_16x16x32_bf16 v[52:55], v[152:155], v[160:163], v[52:55]
    ds_read_b64_tr_b16 v[180:181], v8 offset:4096
    v_rcp_f32 v244, v244
    s_add_u32 s23, s23, 4096
    v_mfma_f32_16x16x32_bf16 v[56:59], v[156:159], v[160:163], v[56:59]
    ds_read_b64_tr_b16 v[182:183], v8 offset:4608
    buffer_load_dwordx4 a[64:67], v14, s[56:59], s23 offen offset:0 sc1
    v_mfma_f32_16x16x32_bf16 v[60:63], v[136:139], v[164:167], v[60:63]
    ds_read_b64_tr_b16 v[184:185], v9 offset:4096
    v_rcp_f32 v246, v246
    v_mfma_f32_16x16x32_bf16 v[64:67], v[140:143], v[164:167], v[64:67]
    v_mfma_f32_16x16x32_bf16 v[68:71], v[144:147], v[164:167], v[68:71]
    ds_read_b64_tr_b16 v[186:187], v9 offset:4608
    v_rcp_f32 v248, v248
    v_mfma_f32_16x16x32_bf16 v[72:75], v[148:151], v[164:167], v[72:75]
    ds_read_b64_tr_b16 v[188:189], v10 offset:4096
    buffer_load_dwordx4 a[68:71], v14, s[56:59], s23 offen offset:1024 sc1
    v_mfma_f32_16x16x32_bf16 v[76:79], v[152:155], v[164:167], v[76:79]
    v_rcp_f32 v250, v250
    v_mfma_f32_16x16x32_bf16 v[80:83], v[156:159], v[164:167], v[80:83]
    ds_read_b64_tr_b16 v[190:191], v10 offset:4608
    v_mfma_f32_16x16x32_bf16 v[84:87], v[136:139], v[168:171], v[84:87]
    ds_read_b64_tr_b16 v[192:193], v11 offset:4096
    v_lshlrev_b32 v245, 16, v240
    v_lshlrev_b32 v247, 16, v241
    v_mfma_f32_16x16x32_bf16 v[88:91], v[140:143], v[168:171], v[88:91]
    ds_read_b64_tr_b16 v[194:195], v11 offset:4608
    v_lshlrev_b32 v249, 16, v242
    buffer_load_dwordx4 a[72:75], v14, s[56:59], s23 offen offset:2048 sc1
    v_mfma_f32_16x16x32_bf16 v[92:95], v[144:147], v[168:171], v[92:95]
    v_lshlrev_b32 v251, 16, v243
    v_mfma_f32_16x16x32_bf16 v[96:99], v[148:151], v[168:171], v[96:99]
    ds_read_b64_tr_b16 v[196:197], v12 offset:4096
    v_mul_f32 v244, s82, v244
    v_mfma_f32_16x16x32_bf16 v[100:103], v[152:155], v[168:171], v[100:103]
    ds_read_b64_tr_b16 v[198:199], v12 offset:4608
    v_mul_f32 v246, s82, v246
    v_mfma_f32_16x16x32_bf16 v[104:107], v[156:159], v[168:171], v[104:107]
    ds_read_b128 v[204:207], v134 offset:2048
    v_mul_f32 v248, s82, v248
    buffer_load_dwordx4 a[76:79], v14, s[56:59], s23 offen offset:3072 sc1
    v_mfma_f32_16x16x32_bf16 v[108:111], v[136:139], v[172:175], v[108:111]
    v_mul_f32 v250, s82, v250
    v_mfma_f32_16x16x32_bf16 v[112:115], v[140:143], v[172:175], v[112:115]
    ds_read_b128 v[208:211], v134 offset:4096
    s_lshr_b32 s4, s64, 1
    v_mfma_f32_16x16x32_bf16 v[116:119], v[144:147], v[172:175], v[116:119]
    ds_read_b128 v[212:215], v134 offset:6144
    s_mul_i32 s4, s4, 384
    s_add_u32 s23, s23, 4096
L_st2:
    s_cbranch_execz L_wb_G
    v_mfma_f32_16x16x32_bf16 v[120:123], v[148:151], v[172:175], v[120:123]
    s_add_u32 s4, s4, 162304
    buffer_load_dwordx4 a[80:83], v14, s[56:59], s23 offen offset:0 sc1
    v_mfma_f32_16x16x32_bf16 v[124:127], v[152:155], v[172:175], v[124:127]
    v_and_b32 v33, 48, v0
    v_mfma_f32_16x16x32_bf16 v[128:131], v[156:159], v[172:175], v[128:131]
    v_add_u32 v33, s4, v33
    s_waitcnt lgkmcnt(0)
    v_mfma_f32_16x16x32_bf16 v[36:39], v[176:179], v[200:203], v[36:39]
    ds_read_b128 v[216:219], v33 offset:0
    v_mfma_f32_16x16x32_bf16 v[40:43], v[180:183], v[200:203], v[40:43]
    buffer_load_dwordx4 a[84:87], v14, s[56:59], s23 offen offset:1024 sc1
    v_mfma_f32_16x16x32_bf16 v[44:47], v[184:187], v[200:203], v[44:47]
    ds_read_b128 v[220:223], v33 offset:64
    v_mfma_f32_16x16x32_bf16 v[48:51], v[188:191], v[200:203], v[48:51]
    ds_read_b128 v[224:227], v33 offset:128
    v_mfma_f32_16x16x32_bf16 v[52:55], v[192:195], v[200:203], v[52:55]
    buffer_load_dwordx4 a[88:91], v14, s[56:59], s23 offen offset:2048 sc1
    v_mfma_f32_16x16x32_bf16 v[56:59], v[196:199], v[200:203], v[56:59]
    ds_read_b128 v[228:231], v33 offset:192
    v_mfma_f32_16x16x32_bf16 v[60:63], v[176:179], v[204:207], v[60:63]
    ds_read_b128 v[232:235], v33 offset:256
    v_mfma_f32_16x16x32_bf16 v[64:67], v[180:183], v[204:207], v[64:67]
    ds_read_b128 v[236:239], v33 offset:320
    v_mfma_f32_16x16x32_bf16 v[68:71], v[184:187], v[204:207], v[68:71]
    buffer_load_dwordx4 a[92:95], v14, s[56:59], s23 offen offset:3072 sc1
    v_mfma_f32_16x16x32_bf16 v[72:75], v[188:191], v[204:207], v[72:75]
    v_mfma_f32_16x16x32_bf16 v[76:79], v[192:195], v[204:207], v[76:79]
    s_add_u32 s23, s23, 4096
    v_mfma_f32_16x16x32_bf16 v[80:83], v[196:199], v[204:207], v[80:83]
    buffer_load_dwordx4 a[96:99], v14, s[56:59], s23 offen offset:0 sc1
    v_mfma_f32_16x16x32_bf16 v[84:87], v[176:179], v[208:211], v[84:87]
    v_mfma_f32_16x16x32_bf16 v[88:91], v[180:183], v[208:211], v[88:91]
    v_mfma_f32_16x16x32_bf16 v[92:95], v[184:187], v[208:211], v[92:95]
    buffer_load_dwordx4 a[100:103], v14, s[56:59], s23 offen offset:1024 sc1
    v_mfma_f32_16x16x32_bf16 v[96:99], v[188:191], v[208:211], v[96:99]
    v_mfma_f32_16x16x32_bf16 v[100:103], v[192:195], v[208:211], v[100:103]
    v_mfma_f32_16x16x32_bf16 v[104:107], v[196:199], v[208:211], v[104:107]
    v_mfma_f32_16x16x32_bf16 v[108:111], v[176:179], v[212:215], v[108:111]
    buffer_load_dwordx4 a[104:107], v14, s[56:59], s23 offen offset:2048 sc1
    v_mfma_f32_16x16x32_bf16 v[112:115], v[180:183], v[212:215], v[112:115]
    v_mfma_f32_16x16x32_bf16 v[116:119], v[184:187], v[212:215], v[116:119]
    v_mfma_f32_16x16x32_bf16 v[120:123], v[188:191], v[212:215], v[120:123]
    buffer_load_dwordx4 a[108:111], v14, s[56:59], s23 offen offset:3072 sc1
    v_mfma_f32_16x16x32_bf16 v[124:127], v[192:195], v[212:215], v[124:127]
    v_mfma_f32_16x16x32_bf16 v[128:131], v[196:199], v[212:215], v[128:131]
    s_waitcnt lgkmcnt(0)
    v_pk_fma_f32 v[36:37], v[216:217], v[244:245], v[36:37] op_sel:[0,1,0] op_sel_hi:[1,1,1] neg_lo:[0,1,0] neg_hi:[0,1,0]
    s_add_u32 s23, s23, 4096
    buffer_load_dwordx4 a[112:115], v14, s[56:59], s23 offen offset:0 sc1
    v_pk_fma_f32 v[38:39], v[218:219], v[244:245], v[38:39] op_sel:[0,1,0] op_sel_hi:[1,1,1] neg_lo:[0,1,0] neg_hi:[0,1,0]
    v_pk_fma_f32 v[40:41], v[220:221], v[244:245], v[40:41] op_sel:[0,1,0] op_sel_hi:[1,1,1] neg_lo:[0,1,0] neg_hi:[0,1,0]
    v_pk_fma_f32 v[42:43], v[222:223], v[244:245], v[42:43] op_sel:[0,1,0] op_sel_hi:[1,1,1] neg_lo:[0,1,0] neg_hi:[0,1,0]
    v_pk_mul_f32 v[36:37], v[36:37], v[244:245] op_sel_hi:[1,0]
    v_pk_mul_f32 v[38:39], v[38:39], v[244:245] op_sel_hi:[1,0]
    v_pk_mul_f32 v[40:41], v[40:41], v[244:245] op_sel_hi:[1,0]
    v_pk_mul_f32 v[42:43], v[42:43], v[244:245] op_sel_hi:[1,0]
    v_exp_f32 v200, v36
    v_exp_f32 v201, v37
    v_exp_f32 v202, v38
    v_exp_f32 v203, v39
    v_exp_f32 v204, v40
    v_exp_f32 v205, v41
    v_exp_f32 v206, v42
    v_exp_f32 v207, v43
    v_pk_fma_f32 v[200:201], v[200:201], s[82:83], s[82:83]
    v_pk_fma_f32 v[202:203], v[202:203], s[82:83], s[82:83]
    v_pk_fma_f32 v[204:205], v[204:205], s[82:83], s[82:83]
    v_pk_fma_f32 v[206:207], v[206:207], s[82:83], s[82:83]
    v_rcp_f32 v200, v200
    v_rcp_f32 v201, v201
    v_rcp_f32 v202, v202
    v_rcp_f32 v203, v203
    v_rcp_f32 v204, v204
    v_rcp_f32 v205, v205
    v_rcp_f32 v206, v206
    v_rcp_f32 v207, v207
    v_pk_mul_f32 v[36:37], v[36:37], v[200:201]
    v_pk_mul_f32 v[38:39], v[38:39], v[202:203]
    v_pk_mul_f32 v[40:41], v[40:41], v[204:205]
    v_pk_mul_f32 v[42:43], v[42:43], v[206:207]
    v_cvt_pk_bf16_f32 v132, v36, v37
    v_cvt_pk_bf16_f32 v133, v38, v39
    v_cvt_pk_bf16_f32 v134, v40, v41
    v_cvt_pk_bf16_f32 v135, v42, v43
    buffer_store_dwordx4 v[132:135], v14, s[56:59], s22 offen offset:0 sc1
    v_pk_fma_f32 v[44:45], v[224:225], v[244:245], v[44:45] op_sel:[0,1,0] op_sel_hi:[1,1,1] neg_lo:[0,1,0] neg_hi:[0,1,0]
    v_pk_fma_f32 v[46:47], v[226:227], v[244:245], v[46:47] op_sel:[0,1,0] op_sel_hi:[1,1,1] neg_lo:[0,1,0] neg_hi:[0,1,0]
    v_pk_fma_f32 v[48:49], v[228:229], v[244:245], v[48:49] op_sel:[0,1,0] op_sel_hi:[1,1,1] neg_lo:[0,1,0] neg_hi:[0,1,0]
    v_pk_fma_f32 v[50:51], v[230:231], v[244:245], v[50:51] op_sel:[0,1,0] op_sel_hi:[1,1,1] neg_lo:[0,1,0] neg_hi:[0,1,0]
    v_pk_mul_f32 v[44:45], v[44:45], v[244:245] op_sel_hi:[1,0]
    v_pk_mul_f32 v[46:47], v[46:47], v[244:245] op_sel_hi:[1,0]
    v_pk_mul_f32 v[48:49], v[48:49], v[244:245] op_sel_hi:[1,0]
    v_pk_mul_f32 v[50:51], v[50:51], v[244:245] op_sel_hi:[1,0]
    v_exp_f32 v208, v44
    v_exp_f32 v209, v45
    v_exp_f32 v210, v46
    v_exp_f32 v211, v47
    v_exp_f32 v212, v48
    v_exp_f32 v213, v49
    v_exp_f32 v214, v50
    v_exp_f32 v215, v51
    v_pk_fma_f32 v[208:209], v[208:209], s[82:83], s[82:83]
    v_pk_fma_f32 v[210:211], v[210:211], s[82:83], s[82:83]
    v_pk_fma_f32 v[212:213], v[212:213], s[82:83], s[82:83]
    buffer_load_dwordx4 a[116:119], v14, s[56:59], s23 offen offset:1024 sc1
    v_pk_fma_f32 v[214:215], v[214:215], s[82:83], s[82:83]
    v_rcp_f32 v208, v208
    v_rcp_f32 v209, v209
    v_rcp_f32 v210, v210
    v_rcp_f32 v211, v211
    v_rcp_f32 v212, v212
    v_rcp_f32 v213, v213
    v_rcp_f32 v214, v214
    v_rcp_f32 v215, v215
    v_pk_mul_f32 v[44:45], v[44:45], v[208:209]
    v_pk_mul_f32 v[46:47], v[46:47], v[210:211]
    v_pk_mul_f32 v[48:49], v[48:49], v[212:213]
    v_pk_mul_f32 v[50:51], v[50:51], v[214:215]
    v_cvt_pk_bf16_f32 v240, v44, v45
    v_cvt_pk_bf16_f32 v241, v46, v47
    v_cvt_pk_bf16_f32 v242, v48, v49
    v_cvt_pk_bf16_f32 v243, v50, v51
    buffer_store_dwordx4 v[240:243], v14, s[56:59], s22 offen offset:1024 sc1
    v_pk_fma_f32 v[52:53], v[232:233], v[244:245], v[52:53] op_sel:[0,1,0] op_sel_hi:[1,1,1] neg_lo:[0,1,0] neg_hi:[0,1,0]
    v_pk_fma_f32 v[54:55], v[234:235], v[244:245], v[54:55] op_sel:[0,1,0] op_sel_hi:[1,1,1] neg_lo:[0,1,0] neg_hi:[0,1,0]
    v_pk_fma_f32 v[56:57], v[236:237], v[244:245], v[56:57] op_sel:[0,1,0] op_sel_hi:[1,1,1] neg_lo:[0,1,0] neg_hi:[0,1,0]
    v_pk_fma_f32 v[58:59], v[238:239], v[244:245], v[58:59] op_sel:[0,1,0] op_sel_hi:[1,1,1] neg_lo:[0,1,0] neg_hi:[0,1,0]
    v_pk_mul_f32 v[52:53], v[52:53], v[244:245] op_sel_hi:[1,0]
    v_pk_mul_f32 v[54:55], v[54:55], v[244:245] op_sel_hi:[1,0]
    v_pk_mul_f32 v[56:57], v[56:57], v[244:245] op_sel_hi:[1,0]
    v_pk_mul_f32 v[58:59], v[58:59], v[244:245] op_sel_hi:[1,0]
    v_exp_f32 v200, v52
    v_exp_f32 v201, v53
    v_exp_f32 v202, v54
    v_exp_f32 v203, v55
    v_exp_f32 v204, v56
    v_exp_f32 v205, v57
    v_exp_f32 v206, v58
    v_exp_f32 v207, v59
    v_pk_fma_f32 v[200:201], v[200:201], s[82:83], s[82:83]
    v_pk_fma_f32 v[202:203], v[202:203], s[82:83], s[82:83]
    v_pk_fma_f32 v[204:205], v[204:205], s[82:83], s[82:83]
    v_pk_fma_f32 v[206:207], v[206:207], s[82:83], s[82:83]
    v_rcp_f32 v200, v200
    v_rcp_f32 v201, v201
    v_rcp_f32 v202, v202
    v_rcp_f32 v203, v203
    v_rcp_f32 v204, v204
    v_rcp_f32 v205, v205
    v_rcp_f32 v206, v206
    v_rcp_f32 v207, v207
    v_pk_mul_f32 v[52:53], v[52:53], v[200:201]
    v_pk_mul_f32 v[54:55], v[54:55], v[202:203]
    v_pk_mul_f32 v[56:57], v[56:57], v[204:205]
    v_pk_mul_f32 v[58:59], v[58:59], v[206:207]
    v_cvt_pk_bf16_f32 v132, v52, v53
    v_cvt_pk_bf16_f32 v133, v54, v55
    v_cvt_pk_bf16_f32 v134, v56, v57
    v_cvt_pk_bf16_f32 v135, v58, v59
    buffer_store_dwordx4 v[132:135], v14, s[56:59], s22 offen offset:2048 sc1
    v_pk_fma_f32 v[60:61], v[216:217], v[246:247], v[60:61] op_sel:[0,1,0] op_sel_hi:[1,1,1] neg_lo:[0,1,0] neg_hi:[0,1,0]
    buffer_load_dwordx4 a[120:123], v14, s[56:59], s23 offen offset:2048 sc1
    v_pk_fma_f32 v[62:63], v[218:219], v[246:247], v[62:63] op_sel:[0,1,0] op_sel_hi:[1,1,1] neg_lo:[0,1,0] neg_hi:[0,1,0]
    v_pk_fma_f32 v[64:65], v[220:221], v[246:247], v[64:65] op_sel:[0,1,0] op_sel_hi:[1,1,1] neg_lo:[0,1,0] neg_hi:[0,1,0]
    v_pk_fma_f32 v[66:67], v[222:223], v[246:247], v[66:67] op_sel:[0,1,0] op_sel_hi:[1,1,1] neg_lo:[0,1,0] neg_hi:[0,1,0]
    v_pk_mul_f32 v[60:61], v[60:61], v[246:247] op_sel_hi:[1,0]
    v_pk_mul_f32 v[62:63], v[62:63], v[246:247] op_sel_hi:[1,0]
    v_pk_mul_f32 v[64:65], v[64:65], v[246:247] op_sel_hi:[1,0]
    v_pk_mul_f32 v[66:67], v[66:67], v[246:247] op_sel_hi:[1,0]
    v_exp_f32 v208, v60
    v_exp_f32 v209, v61
    v_exp_f32 v210, v62
    v_exp_f32 v211, v63
    v_exp_f32 v212, v64
    v_exp_f32 v213, v65
    v_exp_f32 v214, v66
    v_exp_f32 v215, v67
    v_pk_fma_f32 v[208:209], v[208:209], s[82:83], s[82:83]
    v_pk_fma_f32 v[210:211], v[210:211], s[82:83], s[82:83]
    v_pk_fma_f32 v[212:213], v[212:213], s[82:83], s[82:83]
    v_pk_fma_f32 v[214:215], v[214:215], s[82:83], s[82:83]
    v_rcp_f32 v208, v208
    v_rcp_f32 v209, v209
    v_rcp_f32 v210, v210
    v_rcp_f32 v211, v211
    v_rcp_f32 v212, v212
    v_rcp_f32 v213, v213
    v_rcp_f32 v214, v214
    v_rcp_f32 v215, v215
    v_pk_mul_f32 v[60:61], v[60:61], v[208:209]
    v_pk_mul_f32 v[62:63], v[62:63], v[210:211]
    v_pk_mul_f32 v[64:65], v[64:65], v[212:213]
    v_pk_mul_f32 v[66:67], v[66:67], v[214:215]
    s_add_u32 s22, s22, 57344
    v_cvt_pk_bf16_f32 v240, v60, v61
    v_cvt_pk_bf16_f32 v241, v62, v63
    v_cvt_pk_bf16_f32 v242, v64, v65
    v_cvt_pk_bf16_f32 v243, v66, v67
    buffer_store_dwordx4 v[240:243], v14, s[56:59], s22 offen offset:0 sc1
    v_pk_fma_f32 v[68:69], v[224:225], v[246:247], v[68:69] op_sel:[0,1,0] op_sel_hi:[1,1,1] neg_lo:[0,1,0] neg_hi:[0,1,0]
    v_pk_fma_f32 v[70:71], v[226:227], v[246:247], v[70:71] op_sel:[0,1,0] op_sel_hi:[1,1,1] neg_lo:[0,1,0] neg_hi:[0,1,0]
    v_pk_fma_f32 v[72:73], v[228:229], v[246:247], v[72:73] op_sel:[0,1,0] op_sel_hi:[1,1,1] neg_lo:[0,1,0] neg_hi:[0,1,0]
    v_pk_fma_f32 v[74:75], v[230:231], v[246:247], v[74:75] op_sel:[0,1,0] op_sel_hi:[1,1,1] neg_lo:[0,1,0] neg_hi:[0,1,0]
    v_pk_mul_f32 v[68:69], v[68:69], v[246:247] op_sel_hi:[1,0]
    v_pk_mul_f32 v[70:71], v[70:71], v[246:247] op_sel_hi:[1,0]
    v_pk_mul_f32 v[72:73], v[72:73], v[246:247] op_sel_hi:[1,0]
    v_pk_mul_f32 v[74:75], v[74:75], v[246:247] op_sel_hi:[1,0]
    v_exp_f32 v200, v68
    v_exp_f32 v201, v69
    v_exp_f32 v202, v70
    v_exp_f32 v203, v71
    v_exp_f32 v204, v72
    v_exp_f32 v205, v73
    v_exp_f32 v206, v74
    v_exp_f32 v207, v75
    v_pk_fma_f32 v[200:201], v[200:201], s[82:83], s[82:83]
    v_pk_fma_f32 v[202:203], v[202:203], s[82:83], s[82:83]
    v_pk_fma_f32 v[204:205], v[204:205], s[82:83], s[82:83]
    buffer_load_dwordx4 a[124:127], v14, s[56:59], s23 offen offset:3072 sc1
    v_pk_fma_f32 v[206:207], v[206:207], s[82:83], s[82:83]
    v_rcp_f32 v200, v200
    v_rcp_f32 v201, v201
    v_rcp_f32 v202, v202
    v_rcp_f32 v203, v203
    v_rcp_f32 v204, v204
    v_rcp_f32 v205, v205
    v_rcp_f32 v206, v206
    v_rcp_f32 v207, v207
    v_pk_mul_f32 v[68:69], v[68:69], v[200:201]
    v_pk_mul_f32 v[70:71], v[70:71], v[202:203]
    v_pk_mul_f32 v[72:73], v[72:73], v[204:205]
    v_pk_mul_f32 v[74:75], v[74:75], v[206:207]
    v_cvt_pk_bf16_f32 v132, v68, v69
    v_cvt_pk_bf16_f32 v133, v70, v71
    v_cvt_pk_bf16_f32 v134, v72, v73
    v_cvt_pk_bf16_f32 v135, v74, v75
    buffer_store_dwordx4 v[132:135], v14, s[56:59], s22 offen offset:1024 sc1
    v_pk_fma_f32 v[76:77], v[232:233], v[246:247], v[76:77] op_sel:[0,1,0] op_sel_hi:[1,1,1] neg_lo:[0,1,0] neg_hi:[0,1,0]
    v_pk_fma_f32 v[78:79], v[234:235], v[246:247], v[78:79] op_sel:[0,1,0] op_sel_hi:[1,1,1] neg_lo:[0,1,0] neg_hi:[0,1,0]
    v_pk_fma_f32 v[80:81], v[236:237], v[246:247], v[80:81] op_sel:[0,1,0] op_sel_hi:[1,1,1] neg_lo:[0,1,0] neg_hi:[0,1,0]
    v_pk_fma_f32 v[82:83], v[238:239], v[246:247], v[82:83] op_sel:[0,1,0] op_sel_hi:[1,1,1] neg_lo:[0,1,0] neg_hi:[0,1,0]
    v_pk_mul_f32 v[76:77], v[76:77], v[246:247] op_sel_hi:[1,0]
    v_pk_mul_f32 v[78:79], v[78:79], v[246:247] op_sel_hi:[1,0]
    v_pk_mul_f32 v[80:81], v[80:81], v[246:247] op_sel_hi:[1,0]
    v_pk_mul_f32 v[82:83], v[82:83], v[246:247] op_sel_hi:[1,0]
    v_exp_f32 v208, v76
    v_exp_f32 v209, v77
    v_exp_f32 v210, v78
    v_exp_f32 v211, v79
    v_exp_f32 v212, v80
    v_exp_f32 v213, v81
    v_exp_f32 v214, v82
    v_exp_f32 v215, v83
    v_pk_fma_f32 v[208:209], v[208:209], s[82:83], s[82:83]
    v_pk_fma_f32 v[210:211], v[210:211], s[82:83], s[82:83]
    v_pk_fma_f32 v[212:213], v[212:213], s[82:83], s[82:83]
    v_pk_fma_f32 v[214:215], v[214:215], s[82:83], s[82:83]
    v_rcp_f32 v208, v208
    v_rcp_f32 v209, v209
    v_rcp_f32 v210, v210
    v_rcp_f32 v211, v211
    v_rcp_f32 v212, v212
    v_rcp_f32 v213, v213
    v_rcp_f32 v214, v214
    v_rcp_f32 v215, v215
    v_pk_mul_f32 v[76:77], v[76:77], v[208:209]
    v_pk_mul_f32 v[78:79], v[78:79], v[210:211]
    v_pk_mul_f32 v[80:81], v[80:81], v[212:213]
    v_pk_mul_f32 v[82:83], v[82:83], v[214:215]
    v_cvt_pk_bf16_f32 v240, v76, v77
    v_cvt_pk_bf16_f32 v241, v78, v79
    v_cvt_pk_bf16_f32 v242, v80, v81
    v_cvt_pk_bf16_f32 v243, v82, v83
    buffer_store_dwordx4 v[240:243], v14, s[56:59], s22 offen offset:2048 sc1
    v_pk_fma_f32 v[84:85], v[216:217], v[248:249], v[84:85] op_sel:[0,1,0] op_sel_hi:[1,1,1] neg_lo:[0,1,0] neg_hi:[0,1,0]
    s_add_u32 s23, s23, 4096
    buffer_load_dwordx4 a[128:131], v14, s[56:59], s23 offen offset:0 sc1
    v_pk_fma_f32 v[86:87], v[218:219], v[248:249], v[86:87] op_sel:[0,1,0] op_sel_hi:[1,1,1] neg_lo:[0,1,0] neg_hi:[0,1,0]
    v_pk_fma_f32 v[88:89], v[220:221], v[248:249], v[88:89] op_sel:[0,1,0] op_sel_hi:[1,1,1] neg_lo:[0,1,0] neg_hi:[0,1,0]
    v_pk_fma_f32 v[90:91], v[222:223], v[248:249], v[90:91] op_sel:[0,1,0] op_sel_hi:[1,1,1] neg_lo:[0,1,0] neg_hi:[0,1,0]
    v_pk_mul_f32 v[84:85], v[84:85], v[248:249] op_sel_hi:[1,0]
    v_pk_mul_f32 v[86:87], v[86:87], v[248:249] op_sel_hi:[1,0]
    v_pk_mul_f32 v[88:89], v[88:89], v[248:249] op_sel_hi:[1,0]
    v_pk_mul_f32 v[90:91], v[90:91], v[248:249] op_sel_hi:[1,0]
    v_exp_f32 v200, v84
    v_exp_f32 v201, v85
    v_exp_f32 v202, v86
    v_exp_f32 v203, v87
    v_exp_f32 v204, v88
    v_exp_f32 v205, v89
    v_exp_f32 v206, v90
    v_exp_f32 v207, v91
    v_pk_fma_f32 v[200:201], v[200:201], s[82:83], s[82:83]
    v_pk_fma_f32 v[202:203], v[202:203], s[82:83], s[82:83]
    v_pk_fma_f32 v[204:205], v[204:205], s[82:83], s[82:83]
    v_pk_fma_f32 v[206:207], v[206:207], s[82:83], s[82:83]
    v_rcp_f32 v200, v200
    v_rcp_f32 v201, v201
    v_rcp_f32 v202, v202
    v_rcp_f32 v203, v203
    v_rcp_f32 v204, v204
    v_rcp_f32 v205, v205
    v_rcp_f32 v206, v206
    v_rcp_f32 v207, v207
    v_pk_mul_f32 v[84:85], v[84:85], v[200:201]
    v_pk_mul_f32 v[86:87], v[86:87], v[202:203]
    v_pk_mul_f32 v[88:89], v[88:89], v[204:205]
    v_pk_mul_f32 v[90:91], v[90:91], v[206:207]
    s_add_u32 s22, s22, 57344
    v_cvt_pk_bf16_f32 v132, v84, v85
    v_cvt_pk_bf16_f32 v133, v86, v87
    v_cvt_pk_bf16_f32 v134, v88, v89
    v_cvt_pk_bf16_f32 v135, v90, v91
    buffer_store_dwordx4 v[132:135], v14, s[56:59], s22 offen offset:0 sc1
    v_pk_fma_f32 v[92:93], v[224:225], v[248:249], v[92:93] op_sel:[0,1,0] op_sel_hi:[1,1,1] neg_lo:[0,1,0] neg_hi:[0,1,0]
    v_pk_fma_f32 v[94:95], v[226:227], v[248:249], v[94:95] op_sel:[0,1,0] op_sel_hi:[1,1,1] neg_lo:[0,1,0] neg_hi:[0,1,0]
    v_pk_fma_f32 v[96:97], v[228:229], v[248:249], v[96:97] op_sel:[0,1,0] op_sel_hi:[1,1,1] neg_lo:[0,1,0] neg_hi:[0,1,0]
    v_pk_fma_f32 v[98:99], v[230:231], v[248:249], v[98:99] op_sel:[0,1,0] op_sel_hi:[1,1,1] neg_lo:[0,1,0] neg_hi:[0,1,0]
    v_pk_mul_f32 v[92:93], v[92:93], v[248:249] op_sel_hi:[1,0]
    v_pk_mul_f32 v[94:95], v[94:95], v[248:249] op_sel_hi:[1,0]
    v_pk_mul_f32 v[96:97], v[96:97], v[248:249] op_sel_hi:[1,0]
    v_pk_mul_f32 v[98:99], v[98:99], v[248:249] op_sel_hi:[1,0]
    v_exp_f32 v208, v92
    v_exp_f32 v209, v93
    v_exp_f32 v210, v94
    v_exp_f32 v211, v95
    v_exp_f32 v212, v96
    v_exp_f32 v213, v97
    v_exp_f32 v214, v98
    v_exp_f32 v215, v99
    v_pk_fma_f32 v[208:209], v[208:209], s[82:83], s[82:83]
    v_pk_fma_f32 v[210:211], v[210:211], s[82:83], s[82:83]
    v_pk_fma_f32 v[212:213], v[212:213], s[82:83], s[82:83]
    buffer_load_dwordx4 a[132:135], v14, s[56:59], s23 offen offset:1024 sc1
    v_pk_fma_f32 v[214:215], v[214:215], s[82:83], s[82:83]
    v_rcp_f32 v208, v208
    v_rcp_f32 v209, v209
    v_rcp_f32 v210, v210
    v_rcp_f32 v211, v211
    v_rcp_f32 v212, v212
    v_rcp_f32 v213, v213
    v_rcp_f32 v214, v214
    v_rcp_f32 v215, v215
    v_pk_mul_f32 v[92:93], v[92:93], v[208:209]
    v_pk_mul_f32 v[94:95], v[94:95], v[210:211]
    v_pk_mul_f32 v[96:97], v[96:97], v[212:213]
    v_pk_mul_f32 v[98:99], v[98:99], v[214:215]
    v_cvt_pk_bf16_f32 v240, v92, v93
    v_cvt_pk_bf16_f32 v241, v94, v95
    v_cvt_pk_bf16_f32 v242, v96, v97
    v_cvt_pk_bf16_f32 v243, v98, v99
    buffer_store_dwordx4 v[240:243], v14, s[56:59], s22 offen offset:1024 sc1
    v_pk_fma_f32 v[100:101], v[232:233], v[248:249], v[100:101] op_sel:[0,1,0] op_sel_hi:[1,1,1] neg_lo:[0,1,0] neg_hi:[0,1,0]
    v_pk_fma_f32 v[102:103], v[234:235], v[248:249], v[102:103] op_sel:[0,1,0] op_sel_hi:[1,1,1] neg_lo:[0,1,0] neg_hi:[0,1,0]
    v_pk_fma_f32 v[104:105], v[236:237], v[248:249], v[104:105] op_sel:[0,1,0] op_sel_hi:[1,1,1] neg_lo:[0,1,0] neg_hi:[0,1,0]
    v_pk_fma_f32 v[106:107], v[238:239], v[248:249], v[106:107] op_sel:[0,1,0] op_sel_hi:[1,1,1] neg_lo:[0,1,0] neg_hi:[0,1,0]
    v_pk_mul_f32 v[100:101], v[100:101], v[248:249] op_sel_hi:[1,0]
    v_pk_mul_f32 v[102:103], v[102:103], v[248:249] op_sel_hi:[1,0]
    v_pk_mul_f32 v[104:105], v[104:105], v[248:249] op_sel_hi:[1,0]
    v_pk_mul_f32 v[106:107], v[106:107], v[248:249] op_sel_hi:[1,0]
    v_exp_f32 v200, v100
    v_exp_f32 v201, v101
    v_exp_f32 v202, v102
    v_exp_f32 v203, v103
    v_exp_f32 v204, v104
    v_exp_f32 v205, v105
    v_exp_f32 v206, v106
    v_exp_f32 v207, v107
    v_pk_fma_f32 v[200:201], v[200:201], s[82:83], s[82:83]
    v_pk_fma_f32 v[202:203], v[202:203], s[82:83], s[82:83]
    v_pk_fma_f32 v[204:205], v[204:205], s[82:83], s[82:83]
    v_pk_fma_f32 v[206:207], v[206:207], s[82:83], s[82:83]
    v_rcp_f32 v200, v200
    v_rcp_f32 v201, v201
    v_rcp_f32 v202, v202
    v_rcp_f32 v203, v203
    v_rcp_f32 v204, v204
    v_rcp_f32 v205, v205
    v_rcp_f32 v206, v206
    v_rcp_f32 v207, v207
    v_pk_mul_f32 v[100:101], v[100:101], v[200:201]
    v_pk_mul_f32 v[102:103], v[102:103], v[202:203]
    v_pk_mul_f32 v[104:105], v[104:105], v[204:205]
    v_pk_mul_f32 v[106:107], v[106:107], v[206:207]
    v_cvt_pk_bf16_f32 v132, v100, v101
    v_cvt_pk_bf16_f32 v133, v102, v103
    v_cvt_pk_bf16_f32 v134, v104, v105
    v_cvt_pk_bf16_f32 v135, v106, v107
    buffer_store_dwordx4 v[132:135], v14, s[56:59], s22 offen offset:2048 sc1
    v_pk_fma_f32 v[108:109], v[216:217], v[250:251], v[108:109] op_sel:[0,1,0] op_sel_hi:[1,1,1] neg_lo:[0,1,0] neg_hi:[0,1,0]
    buffer_load_dwordx4 a[136:139], v14, s[56:59], s23 offen offset:2048 sc1
    v_pk_fma_f32 v[110:111], v[218:219], v[250:251], v[110:111] op_sel:[0,1,0] op_sel_hi:[1,1,1] neg_lo:[0,1,0] neg_hi:[0,1,0]
    v_pk_fma_f32 v[112:113], v[220:221], v[250:251], v[112:113] op_sel:[0,1,0] op_sel_hi:[1,1,1] neg_lo:[0,1,0] neg_hi:[0,1,0]
    v_pk_fma_f32 v[114:115], v[222:223], v[250:251], v[114:115] op_sel:[0,1,0] op_sel_hi:[1,1,1] neg_lo:[0,1,0] neg_hi:[0,1,0]
    v_pk_mul_f32 v[108:109], v[108:109], v[250:251] op_sel_hi:[1,0]
    v_pk_mul_f32 v[110:111], v[110:111], v[250:251] op_sel_hi:[1,0]
    v_pk_mul_f32 v[112:113], v[112:113], v[250:251] op_sel_hi:[1,0]
    v_pk_mul_f32 v[114:115], v[114:115], v[250:251] op_sel_hi:[1,0]
    v_exp_f32 v208, v108
    v_exp_f32 v209, v109
    v_exp_f32 v210, v110
    v_exp_f32 v211, v111
    v_exp_f32 v212, v112
    v_exp_f32 v213, v113
    v_exp_f32 v214, v114
    v_exp_f32 v215, v115
    v_pk_fma_f32 v[208:209], v[208:209], s[82:83], s[82:83]
    v_pk_fma_f32 v[210:211], v[210:211], s[82:83], s[82:83]
    v_pk_fma_f32 v[212:213], v[212:213], s[82:83], s[82:83]
    v_pk_fma_f32 v[214:215], v[214:215], s[82:83], s[82:83]
    v_rcp_f32 v208, v208
    v_rcp_f32 v209, v209
    v_rcp_f32 v210, v210
    v_rcp_f32 v211, v211
    v_rcp_f32 v212, v212
    v_rcp_f32 v213, v213
    v_rcp_f32 v214, v214
    v_rcp_f32 v215, v215
    v_pk_mul_f32 v[108:109], v[108:109], v[208:209]
    v_pk_mul_f32 v[110:111], v[110:111], v[210:211]
    v_pk_mul_f32 v[112:113], v[112:113], v[212:213]
    v_pk_mul_f32 v[114:115], v[114:115], v[214:215]
    s_add_u32 s22, s22, 57344
    v_cvt_pk_bf16_f32 v240, v108, v109
    v_cvt_pk_bf16_f32 v241, v110, v111
    v_cvt_pk_bf16_f32 v242, v112, v113
    v_cvt_pk_bf16_f32 v243, v114, v115
    buffer_store_dwordx4 v[240:243], v14, s[56:59], s22 offen offset:0 sc1
    v_pk_fma_f32 v[116:117], v[224:225], v[250:251], v[116:117] op_sel:[0,1,0] op_sel_hi:[1,1,1] neg_lo:[0,1,0] neg_hi:[0,1,0]
    v_pk_fma_f32 v[118:119], v[226:227], v[250:251], v[118:119] op_sel:[0,1,0] op_sel_hi:[1,1,1] neg_lo:[0,1,0] neg_hi:[0,1,0]
    v_pk_fma_f32 v[120:121], v[228:229], v[250:251], v[120:121] op_sel:[0,1,0] op_sel_hi:[1,1,1] neg_lo:[0,1,0] neg_hi:[0,1,0]
    v_pk_fma_f32 v[122:123], v[230:231], v[250:251], v[122:123] op_sel:[0,1,0] op_sel_hi:[1,1,1] neg_lo:[0,1,0] neg_hi:[0,1,0]
    v_pk_mul_f32 v[116:117], v[116:117], v[250:251] op_sel_hi:[1,0]
    v_pk_mul_f32 v[118:119], v[118:119], v[250:251] op_sel_hi:[1,0]
    v_pk_mul_f32 v[120:121], v[120:121], v[250:251] op_sel_hi:[1,0]
    v_pk_mul_f32 v[122:123], v[122:123], v[250:251] op_sel_hi:[1,0]
    v_exp_f32 v200, v116
    v_exp_f32 v201, v117
    v_exp_f32 v202, v118
    v_exp_f32 v203, v119
    v_exp_f32 v204, v120
    v_exp_f32 v205, v121
    v_exp_f32 v206, v122
    v_exp_f32 v207, v123
    v_pk_fma_f32 v[200:201], v[200:201], s[82:83], s[82:83]
    v_pk_fma_f32 v[202:203], v[202:203], s[82:83], s[82:83]
    v_pk_fma_f32 v[204:205], v[204:205], s[82:83], s[82:83]
    buffer_load_dwordx4 a[140:143], v14, s[56:59], s23 offen offset:3072 sc1
    v_pk_fma_f32 v[206:207], v[206:207], s[82:83], s[82:83]
    v_rcp_f32 v200, v200
    v_rcp_f32 v201, v201
    v_rcp_f32 v202, v202
    v_rcp_f32 v203, v203
    v_rcp_f32 v204, v204
    v_rcp_f32 v205, v205
    v_rcp_f32 v206, v206
    v_rcp_f32 v207, v207
    v_pk_mul_f32 v[116:117], v[116:117], v[200:201]
    v_pk_mul_f32 v[118:119], v[118:119], v[202:203]
    v_pk_mul_f32 v[120:121], v[120:121], v[204:205]
    v_pk_mul_f32 v[122:123], v[122:123], v[206:207]
    v_cvt_pk_bf16_f32 v132, v116, v117
    v_cvt_pk_bf16_f32 v133, v118, v119
    v_cvt_pk_bf16_f32 v134, v120, v121
    v_cvt_pk_bf16_f32 v135, v122, v123
    buffer_store_dwordx4 v[132:135], v14, s[56:59], s22 offen offset:1024 sc1
    v_pk_fma_f32 v[124:125], v[232:233], v[250:251], v[124:125] op_sel:[0,1,0] op_sel_hi:[1,1,1] neg_lo:[0,1,0] neg_hi:[0,1,0]
    v_pk_fma_f32 v[126:127], v[234:235], v[250:251], v[126:127] op_sel:[0,1,0] op_sel_hi:[1,1,1] neg_lo:[0,1,0] neg_hi:[0,1,0]
    v_pk_fma_f32 v[128:129], v[236:237], v[250:251], v[128:129] op_sel:[0,1,0] op_sel_hi:[1,1,1] neg_lo:[0,1,0] neg_hi:[0,1,0]
    v_pk_fma_f32 v[130:131], v[238:239], v[250:251], v[130:131] op_sel:[0,1,0] op_sel_hi:[1,1,1] neg_lo:[0,1,0] neg_hi:[0,1,0]
    v_pk_mul_f32 v[124:125], v[124:125], v[250:251] op_sel_hi:[1,0]
    v_pk_mul_f32 v[126:127], v[126:127], v[250:251] op_sel_hi:[1,0]
    v_pk_mul_f32 v[128:129], v[128:129], v[250:251] op_sel_hi:[1,0]
    v_pk_mul_f32 v[130:131], v[130:131], v[250:251] op_sel_hi:[1,0]
    v_exp_f32 v208, v124
    v_exp_f32 v209, v125
    v_exp_f32 v210, v126
    v_exp_f32 v211, v127
    v_exp_f32 v212, v128
    v_exp_f32 v213, v129
    v_exp_f32 v214, v130
    v_exp_f32 v215, v131
    v_pk_fma_f32 v[208:209], v[208:209], s[82:83], s[82:83]
    v_pk_fma_f32 v[210:211], v[210:211], s[82:83], s[82:83]
    v_pk_fma_f32 v[212:213], v[212:213], s[82:83], s[82:83]
    v_pk_fma_f32 v[214:215], v[214:215], s[82:83], s[82:83]
    v_rcp_f32 v208, v208
    v_rcp_f32 v209, v209
    v_rcp_f32 v210, v210
    v_rcp_f32 v211, v211
    v_rcp_f32 v212, v212
    v_rcp_f32 v213, v213
    v_rcp_f32 v214, v214
    v_rcp_f32 v215, v215
    v_pk_mul_f32 v[124:125], v[124:125], v[208:209]
    v_pk_mul_f32 v[126:127], v[126:127], v[210:211]
    v_pk_mul_f32 v[128:129], v[128:129], v[212:213]
    v_pk_mul_f32 v[130:131], v[130:131], v[214:215]
    v_cvt_pk_bf16_f32 v240, v124, v125
    v_cvt_pk_bf16_f32 v241, v126, v127
    v_cvt_pk_bf16_f32 v242, v128, v129
    v_cvt_pk_bf16_f32 v243, v130, v131
    buffer_store_dwordx4 v[240:243], v14, s[56:59], s22 offen offset:2048 sc1
    s_lshr_b32 s77, s67, 2
    s_add_u32 s23, s23, 4096
    buffer_load_dwordx4 a[144:147], v14, s[56:59], s23 offen offset:0 sc1
    s_mul_i32 s7, s68, 8
    s_add_u32 s77, s77, s7
    s_mul_i32 s93, s64, 3072
    s_mul_i32 s6, s77, 81920
    s_mul_i32 s7, s64, 20480
    s_add_u32 s6, s6, s7
    s_mul_i32 s7, s78, 160
    s_add_u32 s6, s6, s7
    v_add_u32 v33, 0, v0
    v_mul_u32_u24 v35, 6554, v33
    v_lshrrev_b32 v35, 16, v35
    v_mul_u32_u24 v35, 1120, v35
    v_lshl_add_u32 v35, v33, 4, v35
    v_add_u32 v24, s6, v35
    v_add_u32 v33, 64, v0
    v_mul_u32_u24 v35, 6554, v33
    v_lshrrev_b32 v35, 16, v35
    v_mul_u32_u24 v35, 1120, v35
    buffer_load_dwordx4 a[148:151], v14, s[56:59], s23 offen offset:1024 sc1
    v_lshl_add_u32 v35, v33, 4, v35
    v_add_u32 v25, s6, v35
    v_add_u32 v33, 128, v0
    v_mul_u32_u24 v35, 6554, v33
    v_lshrrev_b32 v35, 16, v35
    v_mul_u32_u24 v35, 1120, v35
    v_lshl_add_u32 v35, v33, 4, v35
    v_add_u32 v26, s6, v35
    v_lshrrev_b32 v33, 5, v0
    v_lshl_or_b32 v26, v33, 31, v26
    v_and_b32 v33, 15, v0
    v_lshrrev_b32 v34, 4, v0
    s_lshr_b32 s4, s64, 1
    s_and_b32 s6, s4, s64
    v_lshl_or_b32 v15, s6, 31, v14
    s_mul_i32 s6, s78, 427
    s_lshr_b32 s6, s6, 5
    v_min_u32 v29, 13, v0
    buffer_load_dwordx4 a[152:155], v14, s[56:59], s23 offen offset:2048 sc1
    v_add_u32 v29, s6, v29
    v_min_u32 v29, 106, v29
    v_lshlrev_b32 v29, 6, v29
    s_mov_b32 s21, 65536
    s_lshr_b32 s6, s77, 1
    s_mul_i32 s20, s6, 1024
    s_add_u32 s20, s20, 32768
    s_mul_i32 s6, s64, 19
    s_lshr_b32 s6, s6, 3
    v_min_u32 v30, 2, v0
    v_add_u32 v30, s6, v30
    v_min_u32 v30, 8, v30
    v_lshlrev_b32 v30, 6, v30
    s_mul_i32 s4, s77, 229376
    s_mul_i32 s7, s64, 14336
    s_add_u32 s4, s4, s7
    s_add_u32 s4, s4, 7831552
    s_add_u32 s6, s64, 1
    s_and_b32 s6, s6, 3
    buffer_load_dwordx4 a[156:159], v14, s[56:59], s23 offen offset:3072 sc1
    s_mul_i32 s84, s6, 15360
    s_add_u32 s84, s84, 12288
    s_mul_i32 s24, s6, 57344
    s_add_u32 s24, s24, s4
    s_add_u32 s6, s64, 2
    s_and_b32 s6, s6, 3
    s_mul_i32 s85, s6, 15360
    s_add_u32 s85, s85, 17408
    s_mul_i32 s25, s6, 57344
    s_add_u32 s25, s25, s4
    s_add_u32 s6, s64, 3
    s_and_b32 s6, s6, 3
    s_mul_i32 s86, s6, 15360
    s_add_u32 s86, s86, 22528
    s_mul_i32 s26, s6, 57344
    s_add_u32 s26, s26, s4
    s_add_u32 s6, s64, 4
    s_and_b32 s6, s6, 3
    s_add_u32 s23, s23, 4096
    buffer_load_dwordx4 a[160:163], v14, s[56:59], s23 offen offset:0 sc1
    s_mul_i32 s27, s6, 57344
    s_add_u32 s27, s27, s4
    s_mul_i32 s6, s64, 15360
    s_add_u32 s6, s6, 12288
    v_add_u32 v20, s6, v14
    v_add_u32 v23, s93, v14
    v_mul_u32_u24 v21, 160, v33
    v_lshl_add_u32 v21, v34, 3, v21
    v_add_u32 v21, s93, v21
    s_lshr_b32 s6, s64, 1
    s_mul_i32 s6, s6, -120
    s_mul_i32 s7, s64, 64
    s_add_u32 s6, s6, s7
    s_add_u32 s6, s6, 73728
    v_lshrrev_b32 v35, 2, v0
    v_lshlrev_b32 v35, 6, v35
    v_add3_u32 v22, v35, v14, s6
    v_and_b32 v35, 64, v16
    buffer_load_dwordx4 a[164:167], v14, s[56:59], s23 offen offset:1024 sc1
    v_xor_b32 v22, v35, v22
    v_and_b32 v35, 64, v31
    v_xor_b32 v27, v35, v27
    s_mul_i32 s94, s64, 1024
    s_add_u32 s94, s94, 73728
    s_mul_i32 s95, s78, 337920
    s_mul_i32 s7, s64, 33792
    s_add_u32 s95, s95, s7
    s_mul_i32 s7, s77, 128
    s_add_u32 s95, s95, s7
    s_add_u32 s95, s95, 2916352
    s_mul_i32 s6, s77, 4
    s_add_u32 s6, s6, s64
    s_lshr_b32 s92, s6, 3
    s_mul_i32 s92, s92, 992
    s_mul_i32 s7, s6, 4
    s_add_u32 s92, s92, s7
    s_add_u32 s92, s92, 16384
    s_waitcnt vmcnt(6)
    s_barrier
    buffer_store_dword v19, v17, s[56:59], s11 offen sc1
    s_add_u32 m0, s93, 0
    s_nop 0
    buffer_load_dwordx4 v24, s[28:31], 0 offen lds
    s_add_u32 m0, s93, 1024
    s_nop 0
    buffer_load_dwordx4 v25, s[28:31], 0 offen lds
    s_add_u32 m0, s93, 2048
    s_nop 0
    buffer_load_dwordx4 v26, s[28:31], 0 offen lds
    buffer_load_dwordx4 a[168:171], v14, s[56:59], s23 offen offset:2048 sc1
    buffer_load_dwordx4 a[172:175], v14, s[56:59], s23 offen offset:3072 sc1
    s_add_u32 s23, s23, 4096
    buffer_load_dwordx4 a[176:179], v14, s[56:59], s23 offen offset:0 sc1
    buffer_load_dwordx4 a[180:183], v14, s[56:59], s23 offen offset:1024 sc1
    buffer_load_dwordx4 a[184:187], v14, s[56:59], s23 offen offset:2048 sc1
    buffer_load_dwordx4 a[188:191], v14, s[56:59], s23 offen offset:3072 sc1
    s_add_u32 s23, s23, 4096
    buffer_load_dwordx4 a[192:195], v14, s[56:59], s23 offen offset:0 sc1
L_st3:
    s_cbranch_execz L_wb_G
    buffer_load_dwordx4 a[196:199], v14, s[56:59], s23 offen offset:1024 sc1
    buffer_load_dwordx4 a[200:203], v14, s[56:59], s23 offen offset:2048 sc1
    buffer_load_dwordx4 a[204:207], v14, s[56:59], s23 offen offset:3072 sc1
    s_add_u32 s23, s23, 4096
    buffer_load_dwordx4 a[208:211], v14, s[56:59], s23 offen offset:0 sc1
    buffer_load_dwordx4 a[212:215], v14, s[56:59], s23 offen offset:1024 sc1
    buffer_load_dwordx4 a[216:219], v14, s[56:59], s23 offen offset:2048 sc1
    buffer_load_dwordx4 a[220:223], v14, s[56:59], s23 offen offset:3072 sc1
    s_add_u32 s23, s23, 4096
    buffer_load_dwordx4 a[224:227], v14, s[56:59], s23 offen offset:0 sc1
    buffer_load_dwordx4 a[228:231], v14, s[56:59], s23 offen offset:1024 sc1
    v_bfrev_b32 v18, 1
    s_mov_b32 s12, 0
    buffer_load_dword v34, v30, s[56:59], s20 offen sc1
    buffer_load_dwordx4 a[232:235], v14, s[56:59], s23 offen offset:2048 sc1
    buffer_load_dwordx4 a[236:239], v14, s[56:59], s23 offen offset:3072 sc1
    s_add_u32 s23, s23, 4096
    buffer_load_dwordx4 a[240:243], v15, s[56:59], s23 offen offset:0 sc1
    buffer_load_dwordx4 a[244:247], v15, s[56:59], s23 offen offset:1024 sc1
    buffer_load_dwordx4 a[248:251], v15, s[56:59], s23 offen offset:2048 sc1
    buffer_load_dwordx4 a[252:255], v15, s[56:59], s23 offen offset:3072 sc1
    s_add_u32 s23, s23, 4096
    buffer_load_dwordx4 v[232:235], v15, s[56:59], s23 offen offset:0 sc1
    buffer_load_dwordx4 v[236:239], v15, s[56:59], s23 offen offset:1024 sc1
    s_waitcnt vmcnt(8)
    v_cmp_ne_u32 vcc, s65, v34
    s_cbranch_vccnz L_spin5
L_ok6:
    buffer_load_dword v12, v28, s[56:59], s92 offen sc1
    buffer_load_dwordx4 v[136:139], v14, s[56:59], s24 offen offset:0 sc1
    buffer_load_dwordx4 v[140:143], v14, s[56:59], s24 offen offset:1024 sc1
    buffer_load_dwordx4 v[144:147], v14, s[56:59], s24 offen offset:2048 sc1
    buffer_load_dwordx4 v[148:151], v14, s[56:59], s24 offen offset:3072 sc1
    s_add_u32 s24, s24, 4096
    buffer_load_dwordx4 v[152:155], v14, s[56:59], s24 offen offset:0 sc1
    buffer_load_dwordx4 v[156:159], v14, s[56:59], s24 offen offset:1024 sc1
    buffer_load_dwordx4 v[160:163], v14, s[56:59], s24 offen offset:2048 sc1
    buffer_load_dwordx4 v[164:167], v14, s[56:59], s24 offen offset:3072 sc1
    buffer_load_dwordx4 v[240:243], v15, s[56:59], s23 offen offset:2048 sc1
    buffer_load_dwordx4 v[244:247], v15, s[56:59], s23 offen offset:3072 sc1
    s_add_u32 s23, s23, 4096
    buffer_load_dwordx4 v[248:251], v15, s[56:59], s23 offen offset:0 sc1
    buffer_load_dwordx4 v[252:255], v15, s[56:59], s23 offen offset:1024 sc1
L_shared:
L_st4:
    s_cbranch_execz L_st5
    s_waitcnt vmcnt(11)
    v_mfma_f32_16x16x32_bf16 v[76:79], a[0:3], v[136:139], 0
    s_add_u32 s24, s24, 4096
    v_mfma_f32_16x16x32_bf16 v[80:83], a[4:7], v[136:139], 0
    buffer_load_dwordx4 v[168:171], v14, s[56:59], s24 offen offset:0 sc1
    v_mfma_f32_16x16x32_bf16 v[84:87], a[8:11], v[136:139], 0
    v_mfma_f32_16x16x32_bf16 v[88:91], a[12:15], v[136:139], 0
    v_mfma_f32_16x16x32_bf16 v[92:95], a[16:19], v[136:139], 0
    ds_read_b64 v[2:3], v21 offset:0
    s_waitcnt vmcnt(11)
    v_mfma_f32_16x16x32_bf16 v[76:79], a[20:23], v[140:143], v[76:79]
    buffer_load_dwordx4 v[172:175], v14, s[56:59], s24 offen offset:1024 sc1
    v_mfma_f32_16x16x32_bf16 v[80:83], a[24:27], v[140:143], v[80:83]
    ds_read_b64 v[4:5], v21 offset:32
    v_mfma_f32_16x16x32_bf16 v[84:87], a[28:31], v[140:143], v[84:87]
    ds_read_b64 v[6:7], v21 offset:64
    v_mfma_f32_16x16x32_bf16 v[88:91], a[32:35], v[140:143], v[88:91]
    buffer_load_dwordx4 v[176:179], v14, s[56:59], s24 offen offset:2048 sc1
    v_mfma_f32_16x16x32_bf16 v[92:95], a[36:39], v[140:143], v[92:95]
    ds_read_b64 v[8:9], v21 offset:96
    s_waitcnt vmcnt(12)
    v_mfma_f32_16x16x32_bf16 v[76:79], a[40:43], v[144:147], v[76:79]
    ds_read_b64 v[10:11], v21 offset:128
    v_and_b32 v228, 0xffff0000, v12
    v_mfma_f32_16x16x32_bf16 v[80:83], a[44:47], v[144:147], v[80:83]
    v_rcp_f32 v228, v228
    buffer_load_dwordx4 v[180:183], v14, s[56:59], s24 offen offset:3072 sc1
    v_mfma_f32_16x16x32_bf16 v[84:87], a[48:51], v[144:147], v[84:87]
    v_mfma_f32_16x16x32_bf16 v[88:91], a[52:55], v[144:147], v[88:91]
    v_lshlrev_b32 v229, 16, v12
    v_mfma_f32_16x16x32_bf16 v[92:95], a[56:59], v[144:147], v[92:95]
    v_mul_f32 v229, v228, -v229
    s_waitcnt vmcnt(12)
    v_mfma_f32_16x16x32_bf16 v[76:79], a[60:63], v[148:151], v[76:79]
    s_add_u32 s24, s24, 4096
    v_mfma_f32_16x16x32_bf16 v[80:83], a[64:67], v[148:151], v[80:83]
    buffer_load_dwordx4 v[184:187], v15, s[56:59], s24 offen offset:0 sc1
    v_mfma_f32_16x16x32_bf16 v[84:87], a[68:71], v[148:151], v[84:87]
    v_mfma_f32_16x16x32_bf16 v[88:91], a[72:75], v[148:151], v[88:91]
    v_mfma_f32_16x16x32_bf16 v[92:95], a[76:79], v[148:151], v[92:95]
    s_waitcnt vmcnt(12)
    v_mfma_f32_16x16x32_bf16 v[76:79], a[80:83], v[152:155], v[76:79]
    buffer_load_dwordx4 v[188:191], v15, s[56:59], s24 offen offset:1024 sc1
    v_mfma_f32_16x16x32_bf16 v[80:83], a[84:87], v[152:155], v[80:83]
    v_mfma_f32_16x16x32_bf16 v[84:87], a[88:91], v[152:155], v[84:87]
    v_mfma_f32_16x16x32_bf16 v[88:91], a[92:95], v[152:155], v[88:91]
    buffer_load_dwordx4 v[192:195], v14, s[56:59], s25 offen offset:0 sc1
    v_mfma_f32_16x16x32_bf16 v[92:95], a[96:99], v[152:155], v[92:95]
    s_waitcnt lgkmcnt(0)
    v_lshlrev_b32 v116, 16, v2
    s_waitcnt vmcnt(13)
    v_mfma_f32_16x16x32_bf16 v[76:79], a[100:103], v[156:159], v[76:79]
    v_mfma_f32_16x16x32_bf16 v[80:83], a[104:107], v[156:159], v[80:83]
    v_and_b32 v117, 0xffff0000, v2
    buffer_load_dwordx4 v[196:199], v14, s[56:59], s25 offen offset:1024 sc1
    v_mfma_f32_16x16x32_bf16 v[84:87], a[108:111], v[156:159], v[84:87]
    v_lshlrev_b32 v118, 16, v3
    v_mfma_f32_16x16x32_bf16 v[88:91], a[112:115], v[156:159], v[88:91]
    v_and_b32 v119, 0xffff0000, v3
    v_mfma_f32_16x16x32_bf16 v[92:95], a[116:119], v[156:159], v[92:95]
    v_lshlrev_b32 v120, 16, v4
    s_waitcnt vmcnt(13)
    v_mfma_f32_16x16x32_bf16 v[76:79], a[120:123], v[160:163], v[76:79]
    v_and_b32 v121, 0xffff0000, v4
    v_mfma_f32_16x16x32_bf16 v[80:83], a[124:127], v[160:163], v[80:83]
    v_lshlrev_b32 v122, 16, v5
    buffer_load_dwordx4 v[136:139], v14, s[56:59], s25 offen offset:2048 sc1
    v_mfma_f32_16x16x32_bf16 v[84:87], a[128:131], v[160:163], v[84:87]
    v_and_b32 v123, 0xffff0000, v5
    v_mfma_f32_16x16x32_bf16 v[88:91], a[132:135], v[160:163], v[88:91]
    v_lshlrev_b32 v124, 16, v6
    v_mfma_f32_16x16x32_bf16 v[92:95], a[136:139], v[160:163], v[92:95]
    v_and_b32 v125, 0xffff0000, v6
    s_waitcnt vmcnt(13)
    v_mfma_f32_16x16x32_bf16 v[76:79], a[140:143], v[164:167], v[76:79]
    buffer_load_dwordx4 v[140:143], v14, s[56:59], s25 offen offset:3072 sc1
    v_mfma_f32_16x16x32_bf16 v[80:83], a[144:147], v[164:167], v[80:83]
    v_lshlrev_b32 v126, 16, v7
    v_mfma_f32_16x16x32_bf16 v[84:87], a[148:151], v[164:167], v[84:87]
    v_and_b32 v127, 0xffff0000, v7
    s_add_u32 s25, s25, 4096
    v_mfma_f32_16x16x32_bf16 v[88:91], a[152:155], v[164:167], v[88:91]
    v_lshlrev_b32 v128, 16, v8
    buffer_load_dwordx4 v[144:147], v14, s[56:59], s25 offen offset:0 sc1
    v_mfma_f32_16x16x32_bf16 v[92:95], a[156:159], v[164:167], v[92:95]
    v_and_b32 v129, 0xffff0000, v8
    s_waitcnt vmcnt(10)
    v_mfma_f32_16x16x32_bf16 v[76:79], a[160:163], v[168:171], v[76:79]
    v_lshlrev_b32 v130, 16, v9
    v_mfma_f32_16x16x32_bf16 v[80:83], a[164:167], v[168:171], v[80:83]
    v_and_b32 v131, 0xffff0000, v9
    buffer_load_dwordx4 v[148:151], v14, s[56:59], s25 offen offset:1024 sc1
    v_mfma_f32_16x16x32_bf16 v[84:87], a[168:171], v[168:171], v[84:87]
    v_lshlrev_b32 v132, 16, v10
    v_mfma_f32_16x16x32_bf16 v[88:91], a[172:175], v[168:171], v[88:91]
    v_and_b32 v133, 0xffff0000, v10
    v_mfma_f32_16x16x32_bf16 v[92:95], a[176:179], v[168:171], v[92:95]
    s_barrier
    buffer_store_dword v19, v18, s[56:59], s12 offen sc1
    s_waitcnt vmcnt(11)
    v_mfma_f32_16x16x32_bf16 v[76:79], a[180:183], v[172:175], v[76:79]
    v_lshlrev_b32 v134, 16, v11
    v_and_b32 v135, 0xffff0000, v11
    v_mfma_f32_16x16x32_bf16 v[80:83], a[184:187], v[172:175], v[80:83]
    buffer_load_dwordx4 v[152:155], v14, s[56:59], s25 offen offset:2048 sc1
    v_mfma_f32_16x16x32_bf16 v[84:87], a[188:191], v[172:175], v[84:87]
    v_fma_f32 v64, v116, v228, v229
    v_mfma_f32_16x16x32_bf16 v[88:91], a[192:195], v[172:175], v[88:91]
    v_fma_f32 v65, v117, v228, v229
    v_mfma_f32_16x16x32_bf16 v[92:95], a[196:199], v[172:175], v[92:95]
    v_fma_f32 v66, v118, v228, v229
    s_waitcnt vmcnt(11)
    v_mfma_f32_16x16x32_bf16 v[76:79], a[200:203], v[176:179], v[76:79]
    v_fma_f32 v67, v119, v228, v229
    buffer_load_dwordx4 v[156:159], v14, s[56:59], s25 offen offset:3072 sc1
    v_mfma_f32_16x16x32_bf16 v[80:83], a[204:207], v[176:179], v[80:83]
    v_fma_f32 v68, v120, v228, v229
    v_mfma_f32_16x16x32_bf16 v[84:87], a[208:211], v[176:179], v[84:87]
    v_fma_f32 v69, v121, v228, v229
    s_add_u32 s25, s25, 4096
    v_mfma_f32_16x16x32_bf16 v[88:91], a[212:215], v[176:179], v[88:91]
    v_fma_f32 v70, v122, v228, v229
    buffer_load_dwordx4 v[160:163], v14, s[56:59], s25 offen offset:0 sc1
    v_mfma_f32_16x16x32_bf16 v[92:95], a[216:219], v[176:179], v[92:95]
    v_fma_f32 v71, v123, v228, v229
    s_waitcnt vmcnt(12)
    v_mfma_f32_16x16x32_bf16 v[76:79], a[220:223], v[180:183], v[76:79]
    v_fma_f32 v72, v124, v228, v229
    v_mfma_f32_16x16x32_bf16 v[80:83], a[224:227], v[180:183], v[80:83]
    v_fma_f32 v73, v125, v228, v229
    buffer_load_dwordx4 v[164:167], v14, s[56:59], s25 offen offset:1024 sc1
    v_mfma_f32_16x16x32_bf16 v[84:87], a[228:231], v[180:183], v[84:87]
    v_mfma_f32_16x16x32_bf16 v[88:91], a[232:235], v[180:183], v[88:91]
    v_fma_f32 v74, v126, v228, v229
    v_mfma_f32_16x16x32_bf16 v[92:95], a[236:239], v[180:183], v[92:95]
    v_fma_f32 v75, v127, v228, v229
    s_waitcnt vmcnt(12)
    v_mfma_f32_16x16x32_bf16 v[76:79], a[240:243], v[184:187], v[76:79]
    v_fma_f32 v220, v128, v228, v229
    v_mfma_f32_16x16x32_bf16 v[80:83], a[244:247], v[184:187], v[80:83]
    v_fma_f32 v221, v129, v228, v229
    buffer_load_dwordx4 v[168:171], v14, s[56:59], s25 offen offset:2048 sc1
    v_mfma_f32_16x16x32_bf16 v[84:87], a[248:251], v[184:187], v[84:87]
    v_fma_f32 v222, v130, v228, v229
    v_mfma_f32_16x16x32_bf16 v[88:91], a[252:255], v[184:187], v[88:91]
    v_fma_f32 v223, v131, v228, v229
    v_mfma_f32_16x16x32_bf16 v[92:95], v[232:235], v[184:187], v[92:95]
    v_fma_f32 v224, v132, v228, v229
    s_waitcnt vmcnt(12)
    v_mfma_f32_16x16x32_bf16 v[76:79], v[236:239], v[188:191], v[76:79]
    v_fma_f32 v225, v133, v228, v229
    v_mfma_f32_16x16x32_bf16 v[80:83], v[240:243], v[188:191], v[80:83]
    v_fma_f32 v226, v134, v228, v229
    buffer_load_dwordx4 v[172:175], v14, s[56:59], s25 offen offset:3072 sc1
    v_mfma_f32_16x16x32_bf16 v[84:87], v[244:247], v[188:191], v[84:87]
    v_fma_f32 v227, v135, v228, v229
    v_mfma_f32_16x16x32_bf16 v[88:91], v[248:251], v[188:191], v[88:91]
    v_mfma_f32_16x16x32_bf16 v[92:95], v[252:255], v[188:191], v[92:95]
    s_waitcnt vmcnt(12)
    v_mfma_f32_16x16x32_bf16 v[44:47], a[0:3], v[192:195], 0
    s_add_u32 s25, s25, 4096
    v_mfma_f32_16x16x32_bf16 v[48:51], a[4:7], v[192:195], 0
    buffer_load_dwordx4 v[176:179], v15, s[56:59], s25 offen offset:0 sc1
    v_mfma_f32_16x16x32_bf16 v[52:55], a[8:11], v[192:195], 0
    v_add_u32 v33, s84, v14
    v_mfma_f32_16x16x32_bf16 v[56:59], a[12:15], v[192:195], 0
    ds_write_b128 v33, v[76:79] offset:0
    v_mfma_f32_16x16x32_bf16 v[60:63], a[16:19], v[192:195], 0
    s_waitcnt vmcnt(12)
    v_mfma_f32_16x16x32_bf16 v[44:47], a[20:23], v[196:199], v[44:47]
    v_mfma_f32_16x16x32_bf16 v[48:51], a[24:27], v[196:199], v[48:51]
    buffer_load_dwordx4 v[180:183], v15, s[56:59], s25 offen offset:1024 sc1
    v_mfma_f32_16x16x32_bf16 v[52:55], a[28:31], v[196:199], v[52:55]
    ds_write_b128 v33, v[80:83] offset:1024
    v_mfma_f32_16x16x32_bf16 v[56:59], a[32:35], v[196:199], v[56:59]
    v_mfma_f32_16x16x32_bf16 v[60:63], a[36:39], v[196:199], v[60:63]
    s_waitcnt vmcnt(12)
    v_mfma_f32_16x16x32_bf16 v[44:47], a[40:43], v[136:139], v[44:47]
    ds_write_b128 v33, v[84:87] offset:2048
    v_mfma_f32_16x16x32_bf16 v[48:51], a[44:47], v[136:139], v[48:51]
    buffer_load_dwordx4 v[184:187], v14, s[56:59], s26 offen offset:0 sc1
    v_mfma_f32_16x16x32_bf16 v[52:55], a[48:51], v[136:139], v[52:55]
    ds_write_b128 v33, v[88:91] offset:3072
    v_mfma_f32_16x16x32_bf16 v[56:59], a[52:55], v[136:139], v[56:59]
    v_mfma_f32_16x16x32_bf16 v[60:63], a[56:59], v[136:139], v[60:63]
    s_waitcnt vmcnt(12)
    v_mfma_f32_16x16x32_bf16 v[44:47], a[60:63], v[140:143], v[44:47]
    ds_write_b128 v33, v[92:95] offset:4096
    v_mfma_f32_16x16x32_bf16 v[48:51], a[64:67], v[140:143], v[48:51]
    buffer_load_dwordx4 v[188:191], v14, s[56:59], s26 offen offset:1024 sc1
    v_mfma_f32_16x16x32_bf16 v[52:55], a[68:71], v[140:143], v[52:55]
    v_mfma_f32_16x16x32_bf16 v[56:59], a[72:75], v[140:143], v[56:59]
    v_mfma_f32_16x16x32_bf16 v[60:63], a[76:79], v[140:143], v[60:63]
    s_waitcnt vmcnt(12)
    v_mfma_f32_16x16x32_bf16 v[44:47], a[80:83], v[144:147], v[44:47]
    v_mfma_f32_16x16x32_bf16 v[48:51], a[84:87], v[144:147], v[48:51]
    buffer_load_dwordx4 v[192:195], v14, s[56:59], s26 offen offset:2048 sc1
    v_mfma_f32_16x16x32_bf16 v[52:55], a[88:91], v[144:147], v[52:55]
    v_mfma_f32_16x16x32_bf16 v[56:59], a[92:95], v[144:147], v[56:59]
    v_mfma_f32_16x16x32_bf16 v[60:63], a[96:99], v[144:147], v[60:63]
    s_waitcnt vmcnt(12)
    v_mfma_f32_16x16x32_bf16 v[44:47], a[100:103], v[148:151], v[44:47]
    v_mfma_f32_16x16x32_bf16 v[48:51], a[104:107], v[148:151], v[48:51]
    buffer_load_dwordx4 v[196:199], v14, s[56:59], s26 offen offset:3072 sc1
    v_mfma_f32_16x16x32_bf16 v[52:55], a[108:111], v[148:151], v[52:55]
    v_mfma_f32_16x16x32_bf16 v[56:59], a[112:115], v[148:151], v[56:59]
    v_mfma_f32_16x16x32_bf16 v[60:63], a[116:119], v[148:151], v[60:63]
    s_waitcnt vmcnt(11)
    v_mfma_f32_16x16x32_bf16 v[44:47], a[120:123], v[152:155], v[44:47]
    s_add_u32 s26, s26, 4096
    v_mfma_f32_16x16x32_bf16 v[48:51], a[124:127], v[152:155], v[48:51]
    buffer_load_dwordx4 v[136:139], v14, s[56:59], s26 offen offset:0 sc1
    v_mfma_f32_16x16x32_bf16 v[52:55], a[128:131], v[152:155], v[52:55]
    v_mfma_f32_16x16x32_bf16 v[56:59], a[132:135], v[152:155], v[56:59]
    v_mfma_f32_16x16x32_bf16 v[60:63], a[136:139], v[152:155], v[60:63]
    s_waitcnt vmcnt(11)
    v_mfma_f32_16x16x32_bf16 v[44:47], a[140:143], v[156:159], v[44:47]
    v_mfma_f32_16x16x32_bf16 v[48:51], a[144:147], v[156:159], v[48:51]
    buffer_load_dwordx4 v[140:143], v14, s[56:59], s26 offen offset:1024 sc1
    v_mfma_f32_16x16x32_bf16 v[52:55], a[148:151], v[156:159], v[52:55]
    v_mfma_f32_16x16x32_bf16 v[56:59], a[152:155], v[156:159], v[56:59]
    v_mfma_f32_16x16x32_bf16 v[60:63], a[156:159], v[156:159], v[60:63]
    s_waitcnt lgkmcnt(0)
    s_barrier
    s_waitcnt vmcnt(11)
    v_mfma_f32_16x16x32_bf16 v[44:47], a[160:163], v[160:163], v[44:47]
    v_add_u32 v33, s86, v14
    v_mfma_f32_16x16x32_bf16 v[48:51], a[164:167], v[160:163], v[48:51]
    v_subrev_u32 v33, 10240, v33
    buffer_load_dwordx4 v[144:147], v14, s[56:59], s26 offen offset:2048 sc1
    v_mfma_f32_16x16x32_bf16 v[52:55], a[168:171], v[160:163], v[52:55]
    ds_read_b128 v[76:79], v33 offset:0
    v_mfma_f32_16x16x32_bf16 v[56:59], a[172:175], v[160:163], v[56:59]
    v_mfma_f32_16x16x32_bf16 v[60:63], a[176:179], v[160:163], v[60:63]
    buffer_load_dword v34, v29, s[56:59], s21 offen sc1
    s_waitcnt vmcnt(12)
    v_mfma_f32_16x16x32_bf16 v[44:47], a[180:183], v[164:167], v[44:47]
    ds_read_b128 v[80:83], v33 offset:1024
    v_mfma_f32_16x16x32_bf16 v[48:51], a[184:187], v[164:167], v[48:51]
    buffer_load_dwordx4 v[148:151], v14, s[56:59], s26 offen offset:3072 sc1
    v_mfma_f32_16x16x32_bf16 v[52:55], a[188:191], v[164:167], v[52:55]
    ds_read_b128 v[84:87], v33 offset:2048
    v_mfma_f32_16x16x32_bf16 v[56:59], a[192:195], v[164:167], v[56:59]
    ds_read_b128 v[88:91], v33 offset:3072
    v_mfma_f32_16x16x32_bf16 v[60:63], a[196:199], v[164:167], v[60:63]
    ds_read_b128 v[92:95], v33 offset:4096
    s_waitcnt vmcnt(12)
    v_mfma_f32_16x16x32_bf16 v[44:47], a[200:203], v[168:171], v[44:47]
    s_add_u32 s26, s26, 4096
    v_mfma_f32_16x16x32_bf16 v[48:51], a[204:207], v[168:171], v[48:51]
    buffer_load_dwordx4 v[152:155], v14, s[56:59], s26 offen offset:0 sc1
    v_mfma_f32_16x16x32_bf16 v[52:55], a[208:211], v[168:171], v[52:55]
    v_mfma_f32_16x16x32_bf16 v[56:59], a[212:215], v[168:171], v[56:59]
    v_mfma_f32_16x16x32_bf16 v[60:63], a[216:219], v[168:171], v[60:63]
    s_waitcnt vmcnt(12)
    v_mfma_f32_16x16x32_bf16 v[44:47], a[220:223], v[172:175], v[44:47]
    v_mfma_f32_16x16x32_bf16 v[48:51], a[224:227], v[172:175], v[48:51]
    buffer_load_dwordx4 v[156:159], v14, s[56:59], s26 offen offset:1024 sc1
    v_mfma_f32_16x16x32_bf16 v[52:55], a[228:231], v[172:175], v[52:55]
    v_mfma_f32_16x16x32_bf16 v[56:59], a[232:235], v[172:175], v[56:59]
    v_mfma_f32_16x16x32_bf16 v[60:63], a[236:239], v[172:175], v[60:63]
    s_waitcnt vmcnt(12)
    v_mfma_f32_16x16x32_bf16 v[44:47], a[240:243], v[176:179], v[44:47]
    v_mfma_f32_16x16x32_bf16 v[48:51], a[244:247], v[176:179], v[48:51]
    buffer_load_dwordx4 v[160:163], v14, s[56:59], s26 offen offset:2048 sc1
    v_mfma_f32_16x16x32_bf16 v[52:55], a[248:251], v[176:179], v[52:55]
    v_mfma_f32_16x16x32_bf16 v[56:59], a[252:255], v[176:179], v[56:59]
    v_mfma_f32_16x16x32_bf16 v[60:63], v[232:235], v[176:179], v[60:63]
    s_waitcnt vmcnt(12)
    v_mfma_f32_16x16x32_bf16 v[44:47], v[236:239], v[180:183], v[44:47]
    v_mfma_f32_16x16x32_bf16 v[48:51], v[240:243], v[180:183], v[48:51]
    buffer_load_dwordx4 v[164:167], v14, s[56:59], s26 offen offset:3072 sc1
    v_mfma_f32_16x16x32_bf16 v[52:55], v[244:247], v[180:183], v[52:55]
    v_mfma_f32_16x16x32_bf16 v[56:59], v[248:251], v[180:183], v[56:59]
    v_mfma_f32_16x16x32_bf16 v[60:63], v[252:255], v[180:183], v[60:63]
    s_waitcnt vmcnt(12) lgkmcnt(0)
    v_mfma_f32_16x16x32_bf16 v[76:79], a[0:3], v[184:187], v[76:79]
    s_add_u32 s26, s26, 4096
    v_mfma_f32_16x16x32_bf16 v[80:83], a[4:7], v[184:187], v[80:83]
    buffer_load_dwordx4 v[168:171], v15, s[56:59], s26 offen offset:0 sc1
    v_mfma_f32_16x16x32_bf16 v[84:87], a[8:11], v[184:187], v[84:87]
    v_add_u32 v33, s85, v14
    v_mfma_f32_16x16x32_bf16 v[88:91], a[12:15], v[184:187], v[88:91]
    ds_write_b128 v33, v[44:47] offset:0
    v_mfma_f32_16x16x32_bf16 v[92:95], a[16:19], v[184:187], v[92:95]
    s_waitcnt vmcnt(12)
    v_mfma_f32_16x16x32_bf16 v[76:79], a[20:23], v[188:191], v[76:79]
    v_mfma_f32_16x16x32_bf16 v[80:83], a[24:27], v[188:191], v[80:83]
    buffer_load_dwordx4 v[172:175], v15, s[56:59], s26 offen offset:1024 sc1
    v_mfma_f32_16x16x32_bf16 v[84:87], a[28:31], v[188:191], v[84:87]
    ds_write_b128 v33, v[48:51] offset:1024
    v_mfma_f32_16x16x32_bf16 v[88:91], a[32:35], v[188:191], v[88:91]
    v_mfma_f32_16x16x32_bf16 v[92:95], a[36:39], v[188:191], v[92:95]
    s_waitcnt vmcnt(12)
    v_mfma_f32_16x16x32_bf16 v[76:79], a[40:43], v[192:195], v[76:79]
    ds_write_b128 v33, v[52:55] offset:2048
    v_mfma_f32_16x16x32_bf16 v[80:83], a[44:47], v[192:195], v[80:83]
    buffer_load_dwordx4 v[176:179], v14, s[56:59], s27 offen offset:0 sc1
    v_mfma_f32_16x16x32_bf16 v[84:87], a[48:51], v[192:195], v[84:87]
    ds_write_b128 v33, v[56:59] offset:3072
    v_mfma_f32_16x16x32_bf16 v[88:91], a[52:55], v[192:195], v[88:91]
    v_mfma_f32_16x16x32_bf16 v[92:95], a[56:59], v[192:195], v[92:95]
    s_waitcnt vmcnt(12)
    v_mfma_f32_16x16x32_bf16 v[76:79], a[60:63], v[196:199], v[76:79]
    ds_write_b128 v33, v[60:63] offset:4096
    v_mfma_f32_16x16x32_bf16 v[80:83], a[64:67], v[196:199], v[80:83]
    buffer_load_dwordx4 v[180:183], v14, s[56:59], s27 offen offset:1024 sc1
    v_mfma_f32_16x16x32_bf16 v[84:87], a[68:71], v[196:199], v[84:87]
    v_mfma_f32_16x16x32_bf16 v[88:91], a[72:75], v[196:199], v[88:91]
    v_mfma_f32_16x16x32_bf16 v[92:95], a[76:79], v[196:199], v[92:95]
    s_waitcnt vmcnt(9)
    v_cmp_ne_u32 vcc, s65, v34
    s_cbranch_vccnz L_spin7
L_ok8:
    v_mfma_f32_16x16x32_bf16 v[76:79], a[80:83], v[136:139], v[76:79]
    v_mfma_f32_16x16x32_bf16 v[80:83], a[84:87], v[136:139], v[80:83]
    s_add_u32 m0, s94, 0
    buffer_load_dwordx4 v[184:187], v14, s[56:59], s27 offen offset:2048 sc1
    v_mfma_f32_16x16x32_bf16 v[84:87], a[88:91], v[136:139], v[84:87]
    s_lshl_b32 s5, s64, 30
    v_mfma_f32_16x16x32_bf16 v[88:91], a[92:95], v[136:139], v[88:91]
    buffer_load_dwordx4 v27, s[56:59], s95 offen sc1 nt lds
    v_mfma_f32_16x16x32_bf16 v[92:95], a[96:99], v[136:139], v[92:95]
    v_mfma_f32_16x16x32_bf16 v[76:79], a[100:103], v[140:143], v[76:79]
    v_mfma_f32_16x16x32_bf16 v[80:83], a[104:107], v[140:143], v[80:83]
    v_bfrev_b32 v35, 1
    buffer_load_dwordx4 v[188:191], v14, s[56:59], s27 offen offset:3072 sc1
    v_mfma_f32_16x16x32_bf16 v[84:87], a[108:111], v[140:143], v[84:87]
    s_add_u32 m0, s94, 4096
    v_mfma_f32_16x16x32_bf16 v[88:91], a[112:115], v[140:143], v[88:91]
    s_add_u32 s95, s95, 135168
    v_mfma_f32_16x16x32_bf16 v[92:95], a[116:119], v[140:143], v[92:95]
    buffer_load_dwordx4 v27, s[56:59], s95 offen sc1 nt lds
    v_mfma_f32_16x16x32_bf16 v[76:79], a[120:123], v[144:147], v[76:79]
    s_add_u32 s27, s27, 4096
    v_mfma_f32_16x16x32_bf16 v[80:83], a[124:127], v[144:147], v[80:83]
    buffer_load_dwordx4 v[192:195], v14, s[56:59], s27 offen offset:0 sc1
    v_mfma_f32_16x16x32_bf16 v[84:87], a[128:131], v[144:147], v[84:87]
    s_add_u32 m0, s94, 8192
    v_mfma_f32_16x16x32_bf16 v[88:91], a[132:135], v[144:147], v[88:91]
    s_add_u32 s95, s95, 135168
    v_mfma_f32_16x16x32_bf16 v[92:95], a[136:139], v[144:147], v[92:95]
    v_and_or_b32 v27, s5, v35, v27
    s_waitcnt vmcnt(13)
    v_mfma_f32_16x16x32_bf16 v[76:79], a[140:143], v[148:151], v[76:79]
    buffer_load_dwordx4 v27, s[56:59], s95 offen sc1 nt lds
    v_mfma_f32_16x16x32_bf16 v[80:83], a[144:147], v[148:151], v[80:83]
    buffer_load_dwordx4 v[196:199], v14, s[56:59], s27 offen offset:1024 sc1
    v_mfma_f32_16x16x32_bf16 v[84:87], a[148:151], v[148:151], v[84:87]
    v_mfma_f32_16x16x32_bf16 v[88:91], a[152:155], v[148:151], v[88:91]
    v_mfma_f32_16x16x32_bf16 v[92:95], a[156:159], v[148:151], v[92:95]
    s_waitcnt lgkmcnt(0)
    s_barrier
    s_waitcnt vmcnt(14)
    v_mfma_f32_16x16x32_bf16 v[76:79], a[160:163], v[152:155], v[76:79]
    ds_read_b128 v[44:47], v20 offset:5120
    v_mfma_f32_16x16x32_bf16 v[80:83], a[164:167], v[152:155], v[80:83]
    buffer_load_dwordx4 v[136:139], v14, s[56:59], s27 offen offset:2048 sc1
    v_mfma_f32_16x16x32_bf16 v[84:87], a[168:171], v[152:155], v[84:87]
    ds_read_b128 v[48:51], v20 offset:6144
    v_mfma_f32_16x16x32_bf16 v[88:91], a[172:175], v[152:155], v[88:91]
    v_mfma_f32_16x16x32_bf16 v[92:95], a[176:179], v[152:155], v[92:95]
    ds_read_b128 v[52:55], v20 offset:7168
    s_waitcnt vmcnt(14)
    v_mfma_f32_16x16x32_bf16 v[76:79], a[180:183], v[156:159], v[76:79]
    v_mfma_f32_16x16x32_bf16 v[80:83], a[184:187], v[156:159], v[80:83]
    buffer_load_dwordx4 v[140:143], v14, s[56:59], s27 offen offset:3072 sc1
    v_mfma_f32_16x16x32_bf16 v[84:87], a[188:191], v[156:159], v[84:87]
    ds_read_b128 v[56:59], v20 offset:8192
    v_mfma_f32_16x16x32_bf16 v[88:91], a[192:195], v[156:159], v[88:91]
    ds_read_b128 v[60:63], v20 offset:9216
    v_mfma_f32_16x16x32_bf16 v[92:95], a[196:199], v[156:159], v[92:95]
    s_waitcnt vmcnt(14)
    v_mfma_f32_16x16x32_bf16 v[76:79], a[200:203], v[160:163], v[76:79]
    s_add_u32 s27, s27, 4096
    v_mfma_f32_16x16x32_bf16 v[80:83], a[204:207], v[160:163], v[80:83]
    buffer_load_dwordx4 v[144:147], v14, s[56:59], s27 offen offset:0 sc1
    v_mfma_f32_16x16x32_bf16 v[84:87], a[208:211], v[160:163], v[84:87]
    v_mfma_f32_16x16x32_bf16 v[88:91], a[212:215], v[160:163], v[88:91]
    v_mfma_f32_16x16x32_bf16 v[92:95], a[216:219], v[160:163], v[92:95]
    s_waitcnt vmcnt(14)
    v_mfma_f32_16x16x32_bf16 v[76:79], a[220:223], v[164:167], v[76:79]
    v_mfma_f32_16x16x32_bf16 v[80:83], a[224:227], v[164:167], v[80:83]
    buffer_load_dwordx4 v[148:151], v14, s[56:59], s27 offen offset:1024 sc1
    v_mfma_f32_16x16x32_bf16 v[84:87], a[228:231], v[164:167], v[84:87]
    v_mfma_f32_16x16x32_bf16 v[88:91], a[232:235], v[164:167], v[88:91]
    v_mfma_f32_16x16x32_bf16 v[92:95], a[236:239], v[164:167], v[92:95]
    s_waitcnt vmcnt(14)
    v_mfma_f32_16x16x32_bf16 v[76:79], a[240:243], v[168:171], v[76:79]
    v_mfma_f32_16x16x32_bf16 v[80:83], a[244:247], v[168:171], v[80:83]
    buffer_load_dwordx4 v[152:155], v14, s[56:59], s27 offen offset:2048 sc1
    v_mfma_f32_16x16x32_bf16 v[84:87], a[248:251], v[168:171], v[84:87]
    v_mfma_f32_16x16x32_bf16 v[88:91], a[252:255], v[168:171], v[88:91]
    v_mfma_f32_16x16x32_bf16 v[92:95], v[232:235], v[168:171], v[92:95]
    s_waitcnt vmcnt(14)
    v_mfma_f32_16x16x32_bf16 v[76:79], v[236:239], v[172:175], v[76:79]
    v_mfma_f32_16x16x32_bf16 v[80:83], v[240:243], v[172:175], v[80:83]
    buffer_load_dwordx4 v[156:159], v14, s[56:59], s27 offen offset:3072 sc1
    v_mfma_f32_16x16x32_bf16 v[84:87], v[244:247], v[172:175], v[84:87]
    v_mfma_f32_16x16x32_bf16 v[88:91], v[248:251], v[172:175], v[88:91]
    v_mfma_f32_16x16x32_bf16 v[92:95], v[252:255], v[172:175], v[92:95]
    s_waitcnt vmcnt(14) lgkmcnt(0)
    v_mfma_f32_16x16x32_bf16 v[44:47], a[0:3], v[176:179], v[44:47]
    s_add_u32 s27, s27, 4096
    v_mfma_f32_16x16x32_bf16 v[48:51], a[4:7], v[176:179], v[48:51]
    buffer_load_dwordx4 v[160:163], v15, s[56:59], s27 offen offset:0 sc1
    v_mfma_f32_16x16x32_bf16 v[52:55], a[8:11], v[176:179], v[52:55]
    v_add_u32 v33, s86, v14
    v_mfma_f32_16x16x32_bf16 v[56:59], a[12:15], v[176:179], v[56:59]
    ds_write_b128 v33, v[76:79] offset:0
    v_mfma_f32_16x16x32_bf16 v[60:63], a[16:19], v[176:179], v[60:63]
    s_waitcnt vmcnt(14)
    v_mfma_f32_16x16x32_bf16 v[44:47], a[20:23], v[180:183], v[44:47]
    v_mfma_f32_16x16x32_bf16 v[48:51], a[24:27], v[180:183], v[48:51]
    buffer_load_dwordx4 v[164:167], v15, s[56:59], s27 offen offset:1024 sc1
    v_mfma_f32_16x16x32_bf16 v[52:55], a[28:31], v[180:183], v[52:55]
    ds_write_b128 v33, v[80:83] offset:1024
    v_mfma_f32_16x16x32_bf16 v[56:59], a[32:35], v[180:183], v[56:59]
    v_mfma_f32_16x16x32_bf16 v[60:63], a[36:39], v[180:183], v[60:63]
    s_waitcnt vmcnt(14)
    v_mfma_f32_16x16x32_bf16 v[44:47], a[40:43], v[184:187], v[44:47]
    ds_write_b128 v33, v[84:87] offset:2048
    v_mfma_f32_16x16x32_bf16 v[48:51], a[44:47], v[184:187], v[48:51]
    v_mfma_f32_16x16x32_bf16 v[52:55], a[48:51], v[184:187], v[52:55]
    ds_write_b128 v33, v[88:91] offset:3072
    v_mfma_f32_16x16x32_bf16 v[56:59], a[52:55], v[184:187], v[56:59]
    v_mfma_f32_16x16x32_bf16 v[60:63], a[56:59], v[184:187], v[60:63]
    s_waitcnt vmcnt(12)
    v_mfma_f32_16x16x32_bf16 v[44:47], a[60:63], v[188:191], v[44:47]
    ds_write_b128 v33, v[92:95] offset:4096
    v_mfma_f32_16x16x32_bf16 v[48:51], a[64:67], v[188:191], v[48:51]
    v_mfma_f32_16x16x32_bf16 v[52:55], a[68:71], v[188:191], v[52:55]
    v_mfma_f32_16x16x32_bf16 v[56:59], a[72:75], v[188:191], v[56:59]
    v_mfma_f32_16x16x32_bf16 v[60:63], a[76:79], v[188:191], v[60:63]
    s_waitcnt vmcnt(9) lgkmcnt(0)
    s_barrier
    v_mfma_f32_16x16x32_bf16 v[44:47], a[80:83], v[192:195], v[44:47]
    ds_read_b64_tr_b16 v[2:3], v22 offset:0
    v_mfma_f32_16x16x32_bf16 v[48:51], a[84:87], v[192:195], v[48:51]
    ds_read_b64_tr_b16 v[4:5], v22 offset:2048
    v_mfma_f32_16x16x32_bf16 v[52:55], a[88:91], v[192:195], v[52:55]
    ds_read_b64_tr_b16 v[6:7], v22 offset:4096
    v_mfma_f32_16x16x32_bf16 v[56:59], a[92:95], v[192:195], v[56:59]
    ds_read_b64_tr_b16 v[8:9], v22 offset:6144
    v_mfma_f32_16x16x32_bf16 v[60:63], a[96:99], v[192:195], v[60:63]
    ds_read_b64_tr_b16 v[10:11], v22 offset:8192
    s_waitcnt vmcnt(8)
    v_mfma_f32_16x16x32_bf16 v[44:47], a[100:103], v[196:199], v[44:47]
    ds_read_b128 v[200:203], v20 offset:10240
    v_mfma_f32_16x16x32_bf16 v[48:51], a[104:107], v[196:199], v[48:51]
    ds_read_b128 v[204:207], v20 offset:11264
    v_mfma_f32_16x16x32_bf16 v[52:55], a[108:111], v[196:199], v[52:55]
    ds_read_b128 v[208:211], v20 offset:12288
    v_mfma_f32_16x16x32_bf16 v[56:59], a[112:115], v[196:199], v[56:59]
    ds_read_b128 v[212:215], v20 offset:13312
    v_mfma_f32_16x16x32_bf16 v[60:63], a[116:119], v[196:199], v[60:63]
    ds_read_b128 v[216:219], v20 offset:14336
    s_waitcnt vmcnt(7)
    v_mfma_f32_16x16x32_bf16 v[44:47], a[120:123], v[136:139], v[44:47]
    s_waitcnt lgkmcnt(5)
    v_lshlrev_b32 v96, 16, v2
    v_and_b32 v97, 0xffff0000, v2
    v_mfma_f32_16x16x32_bf16 v[48:51], a[124:127], v[136:139], v[48:51]
    v_lshlrev_b32 v98, 16, v3
    v_and_b32 v99, 0xffff0000, v3
    v_mfma_f32_16x16x32_bf16 v[52:55], a[128:131], v[136:139], v[52:55]
    v_lshlrev_b32 v100, 16, v4
    v_and_b32 v101, 0xffff0000, v4
    v_mfma_f32_16x16x32_bf16 v[56:59], a[132:135], v[136:139], v[56:59]
    v_lshlrev_b32 v102, 16, v5
    v_and_b32 v103, 0xffff0000, v5
    v_mfma_f32_16x16x32_bf16 v[60:63], a[136:139], v[136:139], v[60:63]
    v_lshlrev_b32 v104, 16, v6
    v_and_b32 v105, 0xffff0000, v6
    s_waitcnt vmcnt(6)
    v_mfma_f32_16x16x32_bf16 v[44:47], a[140:143], v[140:143], v[44:47]
    v_lshlrev_b32 v106, 16, v7
    v_and_b32 v107, 0xffff0000, v7
    v_mfma_f32_16x16x32_bf16 v[48:51], a[144:147], v[140:143], v[48:51]
    v_lshlrev_b32 v108, 16, v8
    v_and_b32 v109, 0xffff0000, v8
    v_mfma_f32_16x16x32_bf16 v[52:55], a[148:151], v[140:143], v[52:55]
    v_lshlrev_b32 v110, 16, v9
    v_and_b32 v111, 0xffff0000, v9
    v_mfma_f32_16x16x32_bf16 v[56:59], a[152:155], v[140:143], v[56:59]
    v_lshlrev_b32 v112, 16, v10
    v_and_b32 v113, 0xffff0000, v10
    v_mfma_f32_16x16x32_bf16 v[60:63], a[156:159], v[140:143], v[60:63]
    v_lshlrev_b32 v114, 16, v11
    v_and_b32 v115, 0xffff0000, v11
    s_waitcnt vmcnt(5)
    v_mfma_f32_16x16x32_bf16 v[44:47], a[160:163], v[144:147], v[44:47]
    v_fmac_f32 v116, v64, v96
    v_fmac_f32 v117, v65, v97
    v_mfma_f32_16x16x32_bf16 v[48:51], a[164:167], v[144:147], v[48:51]
    v_fmac_f32 v118, v66, v98
    v_fmac_f32 v119, v67, v99
    v_mfma_f32_16x16x32_bf16 v[52:55], a[168:171], v[144:147], v[52:55]
    v_fmac_f32 v120, v68, v100
    v_fmac_f32 v121, v69, v101
    v_mfma_f32_16x16x32_bf16 v[56:59], a[172:175], v[144:147], v[56:59]
    v_fmac_f32 v122, v70, v102
    v_fmac_f32 v123, v71, v103
    v_mfma_f32_16x16x32_bf16 v[60:63], a[176:179], v[144:147], v[60:63]
    v_fmac_f32 v124, v72, v104
    v_fmac_f32 v125, v73, v105
    s_waitcnt vmcnt(4)
    v_mfma_f32_16x16x32_bf16 v[44:47], a[180:183], v[148:151], v[44:47]
    v_fmac_f32 v126, v74, v106
    v_fmac_f32 v127, v75, v107
    v_mfma_f32_16x16x32_bf16 v[48:51], a[184:187], v[148:151], v[48:51]
    v_fmac_f32 v128, v220, v108
    v_fmac_f32 v129, v221, v109
    v_mfma_f32_16x16x32_bf16 v[52:55], a[188:191], v[148:151], v[52:55]
    v_fmac_f32 v130, v222, v110
    v_fmac_f32 v131, v223, v111
    v_mfma_f32_16x16x32_bf16 v[56:59], a[192:195], v[148:151], v[56:59]
    v_fmac_f32 v132, v224, v112
    v_fmac_f32 v133, v225, v113
    v_mfma_f32_16x16x32_bf16 v[60:63], a[196:199], v[148:151], v[60:63]
    v_fmac_f32 v134, v226, v114
    v_fmac_f32 v135, v227, v115
    s_waitcnt vmcnt(3)
    v_mfma_f32_16x16x32_bf16 v[44:47], a[200:203], v[152:155], v[44:47]
    s_waitcnt lgkmcnt(0)
    v_add_f32 v116, v116, v200
    v_add_f32 v117, v117, v201
    v_mfma_f32_16x16x32_bf16 v[48:51], a[204:207], v[152:155], v[48:51]
    v_add_f32 v118, v118, v202
    v_add_f32 v119, v119, v203
L_st5:
    s_cbranch_execz L_wret
    v_mfma_f32_16x16x32_bf16 v[52:55], a[208:211], v[152:155], v[52:55]
    v_add_f32 v120, v120, v204
    v_add_f32 v121, v121, v205
    v_mfma_f32_16x16x32_bf16 v[56:59], a[212:215], v[152:155], v[56:59]
    v_add_f32 v122, v122, v206
    v_add_f32 v123, v123, v207
    v_mfma_f32_16x16x32_bf16 v[60:63], a[216:219], v[152:155], v[60:63]
    v_add_f32 v124, v124, v208
    v_add_f32 v125, v125, v209
    s_waitcnt vmcnt(0)
    v_mfma_f32_16x16x32_bf16 v[44:47], a[220:223], v[156:159], v[44:47]
    v_add_f32 v126, v126, v210
    v_add_f32 v127, v127, v211
    v_mfma_f32_16x16x32_bf16 v[44:47], a[240:243], v[160:163], v[44:47]
    v_add_f32 v128, v128, v212
    v_add_f32 v129, v129, v213
    v_mfma_f32_16x16x32_bf16 v[44:47], v[236:239], v[164:167], v[44:47]
    v_add_f32 v130, v130, v214
    v_add_f32 v131, v131, v215
    v_mfma_f32_16x16x32_bf16 v[48:51], a[224:227], v[156:159], v[48:51]
    v_add_f32 v132, v132, v216
    v_add_f32 v133, v133, v217
    v_mfma_f32_16x16x32_bf16 v[48:51], a[244:247], v[160:163], v[48:51]
    v_add_f32 v134, v134, v218
    v_add_f32 v135, v135, v219
    v_mfma_f32_16x16x32_bf16 v[48:51], v[240:243], v[164:167], v[48:51]
    v_add_f32 v116, v44, v116
    v_add_f32 v117, v45, v117
    v_mfma_f32_16x16x32_bf16 v[52:55], a[228:231], v[156:159], v[52:55]
    v_add_f32 v118, v46, v118
    v_add_f32 v119, v47, v119
    v_mfma_f32_16x16x32_bf16 v[52:55], a[248:251], v[160:163], v[52:55]
    v_cvt_pk_bf16_f32 v96, v116, v117
    v_cvt_pk_bf16_f32 v97, v118, v119
    v_mfma_f32_16x16x32_bf16 v[52:55], v[244:247], v[164:167], v[52:55]
    v_add_f32 v120, v48, v120
    ds_write_b64 v21, v[96:97] offset:0
    v_mfma_f32_16x16x32_bf16 v[56:59], a[232:235], v[156:159], v[56:59]
    v_add_f32 v121, v49, v121
    v_add_f32 v122, v50, v122
    v_add_f32 v123, v51, v123
    v_mfma_f32_16x16x32_bf16 v[56:59], a[252:255], v[160:163], v[56:59]
    v_cvt_pk_bf16_f32 v98, v120, v121
    v_cvt_pk_bf16_f32 v99, v122, v123
    v_mfma_f32_16x16x32_bf16 v[56:59], v[248:251], v[164:167], v[56:59]
    v_add_f32 v124, v52, v124
    ds_write_b64 v21, v[98:99] offset:32
    v_mfma_f32_16x16x32_bf16 v[60:63], a[236:239], v[156:159], v[60:63]
    v_add_f32 v125, v53, v125
    v_add_f32 v126, v54, v126
    v_add_f32 v127, v55, v127
    v_mfma_f32_16x16x32_bf16 v[60:63], v[232:235], v[160:163], v[60:63]
    v_cvt_pk_bf16_f32 v100, v124, v125
    v_cvt_pk_bf16_f32 v101, v126, v127
    v_mfma_f32_16x16x32_bf16 v[60:63], v[252:255], v[164:167], v[60:63]
    ds_write_b64 v21, v[100:101] offset:64
    v_add_f32 v128, v56, v128
    v_add_f32 v129, v57, v129
    v_add_f32 v130, v58, v130
    v_add_f32 v131, v59, v131
    v_cvt_pk_bf16_f32 v102, v128, v129
    v_cvt_pk_bf16_f32 v103, v130, v131
    ds_write_b64 v21, v[102:103] offset:96
    v_add_f32 v132, v60, v132
    v_add_f32 v133, v61, v133
    v_add_f32 v134, v62, v134
    v_add_f32 v135, v63, v135
    v_cvt_pk_bf16_f32 v104, v132, v133
    v_cvt_pk_bf16_f32 v105, v134, v135
    ds_write_b64 v21, v[104:105] offset:128
    ds_read_b128 v[200:203], v23 offset:0
    ds_read_b128 v[204:207], v23 offset:1024
    ds_read_b128 v[208:211], v23 offset:2048
    s_waitcnt lgkmcnt(2)
    buffer_store_dwordx4 v[200:203], v24, s[52:55], 0 offen
    s_waitcnt lgkmcnt(1)
    buffer_store_dwordx4 v[204:207], v25, s[52:55], 0 offen
    s_waitcnt lgkmcnt(0)
    buffer_store_dwordx4 v[208:211], v26, s[52:55], 0 offen
    s_endpgm
L_F1:
    s_cmp_eq_u32 s3, 106
    s_cselect_b32 s4, 0, 1
    s_mul_i32 s5, s3, 3
    s_add_u32 s5, s5, s4
    s_mul_i32 s4, s5, 205
    s_lshr_b32 s4, s4, 11
    s_mul_i32 s7, s4, -10
    s_add_u32 s5, s5, s7
    s_mul_i32 s6, s4, 81920
    s_mul_i32 s7, s5, 128
    s_add_u32 s6, s6, s7
    v_add_u32 v233, s6, v238
    s_lshl_b32 s6, s5, 9
    v_lshl_add_u32 v234, v31, 2, s6
    v_subrev_u32 v232, 3840, v233
    v_min_u32 v232, 0x80000000, v232
    s_mul_i32 s97, s5, 270336
    s_mul_i32 s7, s64, 67584
    s_add_u32 s97, s97, s7
    s_mul_i32 s7, s4, -128
    s_add_u32 s97, s97, s7
    s_add_u32 s97, s97, 216960
    buffer_load_dwordx4 v[88:91], v234, s[60:63], 0 offen
    buffer_load_dword v68, v232, s[32:35], 0 offen offset:0
    buffer_load_dword v69, v232, s[32:35], 0 offen offset:1280
    buffer_load_dword v70, v232, s[32:35], 0 offen offset:2560
    buffer_load_dword v71, v233, s[32:35], 0 offen offset:0
    buffer_load_dword v72, v233, s[32:35], 0 offen offset:1280
    buffer_load_dword v73, v233, s[32:35], 0 offen offset:2560
    buffer_load_dword v74, v233, s[32:35], 0 offen offset:3840
    buffer_load_dword v75, v233, s[32:35], s0 offen offset:0
    buffer_load_dword v76, v233, s[32:35], s0 offen offset:1280
    buffer_load_dword v77, v233, s[32:35], s0 offen offset:2560
    buffer_load_dword v78, v233, s[32:35], s0 offen offset:3840
    buffer_load_dword v79, v233, s[36:39], 0 offen offset:0 nt
    buffer_load_dword v80, v233, s[36:39], 0 offen offset:1280 nt
    buffer_load_dword v81, v233, s[36:39], 0 offen offset:2560 nt
    buffer_load_dword v82, v233, s[36:39], 0 offen offset:3840 nt
    buffer_load_dword v83, v233, s[36:39], s0 offen offset:0 nt
    buffer_load_dword v84, v233, s[36:39], s0 offen offset:1280 nt
    buffer_load_dword v85, v233, s[36:39], s0 offen offset:2560 nt
    buffer_load_dword v86, v233, s[36:39], s0 offen offset:3840 nt
    s_mov_b64 s[44:45], s[20:21]
    s_mov_b64 s[52:53], s[22:23]
    s_mov_b32 s8, 0x40000
    v_lshlrev_b32 v14, 4, v0
    v_lshlrev_b32 v16, 3, v0
    v_lshrrev_b32 v34, 4, v0
    v_or_b32 v35, s64, v34
    v_min_u32 v35, 1, v35
    v_lshl_or_b32 v17, v35, 31, v31
    v_and_b32 v33, 15, v0
    v_lshlrev_b32 v28, 6, v33
    v_lshrrev_b32 v35, 3, v0
    v_mul_u32_u24 v35, 4096, v35
    v_add_u32 v27, v35, v14
    v_lshrrev_b32 v33, 5, v0
    s_lshl_b32 s6, s64, 1
    s_sub_u32 s6, 7, s6
    v_sub_u32 v33, s6, v33
    v_xor_b32 v33, v33, v0
    v_and_b32 v33, 7, v33
    v_lshlrev_b32 v33, 4, v33
    v_lshl_add_u32 v33, v31, 6, v33
    v_add_u32 v235, 45568, v33
    v_and_b32 v33, 48, v0
    v_xor_b32 v33, v33, v14
    s_mul_i32 s6, s64, 2048
    s_add_u32 s6, s6, 45568
    v_add_u32 v236, s6, v33
    v_xor_b32 v237, 64, v236
    s_cmp_ge_u32 s3, 107
    s_cselect_b32 s6, 0x80000000, 0
    v_or_b32 v6, s6, v27
    s_mul_i32 s9, s3, 64
    s_add_u32 s9, s9, 8192
    s_cmp_ge_u32 s3, 108
    s_cselect_b32 s6, 0x80000000, 0
    v_lshl_or_b32 v8, v0, 4, s6
    s_lshr_b32 s4, s3, 1
    s_and_b32 s5, s3, 1
    s_mul_i32 s6, s4, 40960
    s_mul_i32 s7, s5, 640
    s_add_u32 s6, s6, s7
    s_mul_i32 s7, s64, 10240
    s_add_u32 s6, s6, s7
    s_mul_i32 s99, s4, 5120
    s_mul_i32 s7, s5, 1105920
    s_add_u32 s99, s99, s7
    s_mul_i32 s7, s64, 276480
    s_add_u32 s99, s99, s7
    s_add_u32 s99, s99, 5619712
    v_lshrrev_b32 v33, 3, v0
    v_mul_u32_u24 v34, 1280, v33
    v_and_b32 v33, 6, v33
    v_xor_b32 v33, v33, v0
    v_and_b32 v33, 7, v33
    v_lshlrev_b32 v33, 4, v33
    v_add3_u32 v7, v33, v34, s6
    s_mul_i32 s76, s64, 1024
    s_add_u32 s76, s76, 136704
L_wa_F:
    s_mov_b32 s101, 1
    s_mov_b64 exec, 0
    s_cmp_eq_u32 s64, 0
    s_cbranch_scc1 L_st6
    s_cmp_eq_u32 s64, 1
    s_cbranch_scc1 L_st7
    s_cmp_eq_u32 s64, 2
    s_cbranch_scc1 L_st8
    s_branch L_st4
L_wb_F:
    s_mov_b64 exec, -1
    s_cmp_eq_u32 s3, 106
    s_cselect_b32 s4, 1, 2
    s_mul_i32 s5, s3, 3
    s_add_u32 s5, s5, s4
    s_mul_i32 s4, s5, 205
    s_lshr_b32 s4, s4, 11
    s_mul_i32 s7, s4, -10
    s_add_u32 s5, s5, s7
    s_mul_i32 s6, s4, 81920
    s_mul_i32 s7, s5, 128
    s_add_u32 s6, s6, s7
    v_add_u32 v233, s6, v238
    s_lshl_b32 s6, s5, 9
    v_lshl_add_u32 v234, v31, 2, s6
    v_subrev_u32 v232, 3840, v233
    v_min_u32 v232, 0x80000000, v232
    s_mul_i32 s98, s5, 270336
    s_mul_i32 s7, s64, 67584
    s_add_u32 s98, s98, s7
    s_mul_i32 s7, s4, -128
    s_add_u32 s98, s98, s7
    s_add_u32 s98, s98, 216960
    buffer_load_dwordx4 v[112:115], v234, s[60:63], 0 offen
    buffer_load_dword v92, v232, s[32:35], 0 offen offset:0
    buffer_load_dword v93, v232, s[32:35], 0 offen offset:1280
    buffer_load_dword v94, v232, s[32:35], 0 offen offset:2560
    buffer_load_dword v95, v233, s[32:35], 0 offen offset:0
    buffer_load_dword v96, v233, s[32:35], 0 offen offset:1280
    buffer_load_dword v97, v233, s[32:35], 0 offen offset:2560
    buffer_load_dword v98, v233, s[32:35], 0 offen offset:3840
    buffer_load_dword v99, v233, s[32:35], s0 offen offset:0
    buffer_load_dword v100, v233, s[32:35], s0 offen offset:1280
    buffer_load_dword v101, v233, s[32:35], s0 offen offset:2560
    buffer_load_dword v102, v233, s[32:35], s0 offen offset:3840
    buffer_load_dword v103, v233, s[36:39], 0 offen offset:0 nt
    buffer_load_dword v104, v233, s[36:39], 0 offen offset:1280 nt
    buffer_load_dword v105, v233, s[36:39], 0 offen offset:2560 nt
    buffer_load_dword v106, v233, s[36:39], 0 offen offset:3840 nt
    buffer_load_dword v107, v233, s[36:39], s0 offen offset:0 nt
    buffer_load_dword v108, v233, s[36:39], s0 offen offset:1280 nt
    buffer_load_dword v109, v233, s[36:39], s0 offen offset:2560 nt
    buffer_load_dword v110, v233, s[36:39], s0 offen offset:3840 nt
    s_waitcnt vmcnt(48)
    v_lshlrev_b32 v224, 16, v64
    v_lshlrev_b32 v225, 16, v66
    s_add_u32 m0, s76, 0
    s_nop 0
    buffer_load_dwordx4 v7, s[44:47], 0 offen offset:0 nt lds
    v_and_b32 v226, 0xffff0000, v64
    v_and_b32 v227, 0xffff0000, v66
    v_lshlrev_b32 v228, 16, v65
    v_lshlrev_b32 v229, 16, v67
    v_and_b32 v230, 0xffff0000, v65
    v_and_b32 v231, 0xffff0000, v67
    v_lshlrev_b32 v170, 16, v44
    v_and_b32 v171, 0xffff0000, v44
    v_lshlrev_b32 v172, 16, v45
    v_and_b32 v173, 0xffff0000, v45
    v_lshlrev_b32 v174, 16, v46
    v_and_b32 v175, 0xffff0000, v46
    v_lshlrev_b32 v176, 16, v47
    v_and_b32 v177, 0xffff0000, v47
    v_lshlrev_b32 v178, 16, v48
    v_and_b32 v179, 0xffff0000, v48
    s_add_u32 m0, s76, 3968
    s_nop 0
    buffer_load_dwordx4 v7, s[44:47], 0 offen offset:128 nt lds
    v_lshlrev_b32 v180, 16, v49
    v_and_b32 v181, 0xffff0000, v49
    v_lshlrev_b32 v182, 16, v50
    v_and_b32 v183, 0xffff0000, v50
    v_lshlrev_b32 v184, 16, v51
    v_and_b32 v185, 0xffff0000, v51
    v_lshlrev_b32 v186, 16, v52
    v_and_b32 v187, 0xffff0000, v52
    v_lshlrev_b32 v188, 16, v53
    v_and_b32 v189, 0xffff0000, v53
    v_lshlrev_b32 v190, 16, v54
    v_and_b32 v191, 0xffff0000, v54
    v_pk_mul_f32 v[140:141], v[176:177], v[224:225]
    v_pk_mul_f32 v[142:143], v[178:179], v[224:225]
    v_pk_mul_f32 v[144:145], v[180:181], v[224:225]
    v_pk_mul_f32 v[146:147], v[182:183], v[224:225]
    s_add_u32 m0, s76, 7936
    s_nop 0
    buffer_load_dwordx4 v7, s[44:47], 0 offen offset:256 nt lds
    v_pk_mul_f32 v[148:149], v[184:185], v[224:225]
    v_pk_mul_f32 v[150:151], v[186:187], v[224:225]
    v_pk_mul_f32 v[152:153], v[188:189], v[224:225]
    v_pk_mul_f32 v[154:155], v[190:191], v[224:225]
    v_pk_fma_f32 v[140:141], v[174:175], v[226:227], v[140:141]
    v_pk_fma_f32 v[142:143], v[176:177], v[226:227], v[142:143]
    v_pk_fma_f32 v[144:145], v[178:179], v[226:227], v[144:145]
    v_pk_fma_f32 v[146:147], v[180:181], v[226:227], v[146:147]
    v_pk_fma_f32 v[148:149], v[182:183], v[226:227], v[148:149]
    v_pk_fma_f32 v[150:151], v[184:185], v[226:227], v[150:151]
    v_pk_fma_f32 v[152:153], v[186:187], v[226:227], v[152:153]
    v_pk_fma_f32 v[154:155], v[188:189], v[226:227], v[154:155]
    v_pk_fma_f32 v[140:141], v[172:173], v[228:229], v[140:141]
    v_pk_fma_f32 v[142:143], v[174:175], v[228:229], v[142:143]
    v_pk_fma_f32 v[144:145], v[176:177], v[228:229], v[144:145]
    v_pk_fma_f32 v[146:147], v[178:179], v[228:229], v[146:147]
    v_pk_fma_f32 v[148:149], v[180:181], v[228:229], v[148:149]
    s_add_u32 m0, s76, 11904
    s_nop 0
    buffer_load_dwordx4 v7, s[44:47], 0 offen offset:384 nt lds
    v_pk_fma_f32 v[150:151], v[182:183], v[228:229], v[150:151]
    v_pk_fma_f32 v[152:153], v[184:185], v[228:229], v[152:153]
    v_pk_fma_f32 v[154:155], v[186:187], v[228:229], v[154:155]
    v_pk_fma_f32 v[140:141], v[170:171], v[230:231], v[140:141]
    v_pk_fma_f32 v[142:143], v[172:173], v[230:231], v[142:143]
    v_pk_fma_f32 v[144:145], v[174:175], v[230:231], v[144:145]
    v_pk_fma_f32 v[146:147], v[176:177], v[230:231], v[146:147]
    v_pk_fma_f32 v[148:149], v[178:179], v[230:231], v[148:149]
    v_pk_fma_f32 v[150:151], v[180:181], v[230:231], v[150:151]
    v_pk_fma_f32 v[152:153], v[182:183], v[230:231], v[152:153]
    v_pk_fma_f32 v[154:155], v[184:185], v[230:231], v[154:155]
    s_waitcnt vmcnt(44)
    v_lshlrev_b32 v170, 16, v55
    v_and_b32 v171, 0xffff0000, v55
    v_lshlrev_b32 v172, 16, v56
    v_and_b32 v173, 0xffff0000, v56
    s_add_u32 m0, s76, 15872
    s_nop 0
    buffer_load_dwordx4 v7, s[44:47], 0 offen offset:512 nt lds
    v_lshlrev_b32 v174, 16, v57
    v_and_b32 v175, 0xffff0000, v57
    v_lshlrev_b32 v176, 16, v58
    v_and_b32 v177, 0xffff0000, v58
    v_lshlrev_b32 v178, 16, v59
    v_and_b32 v179, 0xffff0000, v59
    v_lshlrev_b32 v180, 16, v60
    v_and_b32 v181, 0xffff0000, v60
    v_lshlrev_b32 v182, 16, v61
    v_and_b32 v183, 0xffff0000, v61
    v_lshlrev_b32 v184, 16, v62
    v_and_b32 v185, 0xffff0000, v62
    v_pk_mul_f32 v[140:141], v[140:141], v[170:171]
    v_pk_mul_f32 v[142:143], v[142:143], v[172:173]
    v_pk_mul_f32 v[144:145], v[144:145], v[174:175]
    v_pk_mul_f32 v[146:147], v[146:147], v[176:177]
    v_pk_mul_f32 v[148:149], v[148:149], v[178:179]
    v_pk_mul_f32 v[150:151], v[150:151], v[180:181]
    v_pk_mul_f32 v[152:153], v[152:153], v[182:183]
    v_pk_mul_f32 v[154:155], v[154:155], v[184:185]
    v_cvt_pk_bf16_f32 v44, v154, v152
    v_cvt_pk_bf16_f32 v45, v150, v148
    v_cvt_pk_bf16_f32 v46, v146, v144
    v_cvt_pk_bf16_f32 v47, v142, v140
    ds_write_b128 v235, v[44:47] offset:0
    v_cvt_pk_bf16_f32 v48, v155, v153
    v_cvt_pk_bf16_f32 v49, v151, v149
    v_cvt_pk_bf16_f32 v50, v147, v145
    v_cvt_pk_bf16_f32 v51, v143, v141
    ds_write_b128 v235, v[48:51] offset:128
    s_waitcnt lgkmcnt(0)
    s_barrier
    ds_read_b128 v[44:47], v236 offset:0
    ds_read_b128 v[48:51], v237 offset:1024
    s_mul_i32 s65, s65, 0x9e3779b1
    s_add_u32 s65, s65, 0x7f4a7c15
    v_mov_b32 v19, s65
    s_lshl_b32 s4, s64, 3
    s_lshr_b32 s17, s17, s4
    s_lshl_b32 s17, s17, 16
    s_andn2_b32 s17, s17, s80
    s_and_b64 s[72:73], s[72:73], s[80:81]
    s_lshr_b32 s18, s18, s4
    s_lshl_b32 s18, s18, 16
    s_andn2_b32 s18, s18, s80
    s_and_b64 s[74:75], s[74:75], s[80:81]
    s_lshr_b32 s19, s19, s4
    s_lshl_b32 s19, s19, 16
    s_andn2_b32 s19, s19, s80
    s_and_b64 s[82:83], s[82:83], s[80:81]
    s_waitcnt vmcnt(33)
    v_lshlrev_b32 v224, 16, v88
    v_lshlrev_b32 v225, 16, v90
    buffer_load_dwordx4 v[204:207], v14, s[48:51], s89 offen nt
    buffer_load_dwordx4 v[208:211], v14, s[48:51], s89 offen offset:1024 nt
    v_and_b32 v226, 0xffff0000, v88
    v_and_b32 v227, 0xffff0000, v90
    v_lshlrev_b32 v228, 16, v89
    v_lshlrev_b32 v229, 16, v91
    v_and_b32 v230, 0xffff0000, v89
    v_and_b32 v231, 0xffff0000, v91
    v_lshlrev_b32 v170, 16, v68
    v_and_b32 v171, 0xffff0000, v68
    v_lshlrev_b32 v172, 16, v69
    v_and_b32 v173, 0xffff0000, v69
    v_lshlrev_b32 v174, 16, v70
    v_and_b32 v175, 0xffff0000, v70
    v_lshlrev_b32 v176, 16, v71
    v_and_b32 v177, 0xffff0000, v71
    v_lshlrev_b32 v178, 16, v72
    v_and_b32 v179, 0xffff0000, v72
    v_lshlrev_b32 v180, 16, v73
    v_and_b32 v181, 0xffff0000, v73
    v_lshlrev_b32 v182, 16, v74
    v_and_b32 v183, 0xffff0000, v74
    v_lshlrev_b32 v184, 16, v75
    v_and_b32 v185, 0xffff0000, v75
    v_lshlrev_b32 v186, 16, v76
    v_and_b32 v187, 0xffff0000, v76
    v_lshlrev_b32 v188, 16, v77
    v_and_b32 v189, 0xffff0000, v77
    v_lshlrev_b32 v190, 16, v78
    s_waitcnt lgkmcnt(1)
    buffer_store_dwordx4 v[44:47], v6, s[56:59], s96 offen sc1
    v_and_b32 v191, 0xffff0000, v78
    v_pk_mul_f32 v[140:141], v[176:177], v[224:225]
    v_pk_mul_f32 v[142:143], v[178:179], v[224:225]
    v_pk_mul_f32 v[144:145], v[180:181], v[224:225]
    v_pk_mul_f32 v[146:147], v[182:183], v[224:225]
    v_pk_mul_f32 v[148:149], v[184:185], v[224:225]
    v_pk_mul_f32 v[150:151], v[186:187], v[224:225]
    v_pk_mul_f32 v[152:153], v[188:189], v[224:225]
    v_pk_mul_f32 v[154:155], v[190:191], v[224:225]
    v_pk_fma_f32 v[140:141], v[174:175], v[226:227], v[140:141]
    v_pk_fma_f32 v[142:143], v[176:177], v[226:227], v[142:143]
    v_pk_fma_f32 v[144:145], v[178:179], v[226:227], v[144:145]
    v_pk_fma_f32 v[146:147], v[180:181], v[226:227], v[146:147]
    v_pk_fma_f32 v[148:149], v[182:183], v[226:227], v[148:149]
    v_pk_fma_f32 v[150:151], v[184:185], v[226:227], v[150:151]
    v_pk_fma_f32 v[152:153], v[186:187], v[226:227], v[152:153]
    v_pk_fma_f32 v[154:155], v[188:189], v[226:227], v[154:155]
    v_pk_fma_f32 v[140:141], v[172:173], v[228:229], v[140:141]
    v_pk_fma_f32 v[142:143], v[174:175], v[228:229], v[142:143]
    v_pk_fma_f32 v[144:145], v[176:177], v[228:229], v[144:145]
    v_pk_fma_f32 v[146:147], v[178:179], v[228:229], v[146:147]
    v_pk_fma_f32 v[148:149], v[180:181], v[228:229], v[148:149]
    v_pk_fma_f32 v[150:151], v[182:183], v[228:229], v[150:151]
    v_pk_fma_f32 v[152:153], v[184:185], v[228:229], v[152:153]
    v_pk_fma_f32 v[154:155], v[186:187], v[228:229], v[154:155]
    v_pk_fma_f32 v[140:141], v[170:171], v[230:231], v[140:141]
    v_pk_fma_f32 v[142:143], v[172:173], v[230:231], v[142:143]
    s_add_u32 s96, s96, 33792
    s_waitcnt lgkmcnt(0)
    buffer_store_dwordx4 v[48:51], v6, s[56:59], s96 offen sc1
    v_pk_fma_f32 v[144:145], v[174:175], v[230:231], v[144:145]
    v_pk_fma_f32 v[146:147], v[176:177], v[230:231], v[146:147]
    v_pk_fma_f32 v[148:149], v[178:179], v[230:231], v[148:149]
    v_pk_fma_f32 v[150:151], v[180:181], v[230:231], v[150:151]
    v_pk_fma_f32 v[152:153], v[182:183], v[230:231], v[152:153]
    v_pk_fma_f32 v[154:155], v[184:185], v[230:231], v[154:155]
    s_waitcnt vmcnt(29)
    v_lshlrev_b32 v170, 16, v79
    v_and_b32 v171, 0xffff0000, v79
    v_lshlrev_b32 v172, 16, v80
    v_and_b32 v173, 0xffff0000, v80
    v_lshlrev_b32 v174, 16, v81
    v_and_b32 v175, 0xffff0000, v81
    v_lshlrev_b32 v176, 16, v82
    v_and_b32 v177, 0xffff0000, v82
    v_lshlrev_b32 v178, 16, v83
    v_and_b32 v179, 0xffff0000, v83
    v_lshlrev_b32 v180, 16, v84
    v_and_b32 v181, 0xffff0000, v84
    v_lshlrev_b32 v182, 16, v85
    v_and_b32 v183, 0xffff0000, v85
    v_lshlrev_b32 v184, 16, v86
    v_and_b32 v185, 0xffff0000, v86
    v_pk_mul_f32 v[140:141], v[140:141], v[170:171]
    v_pk_mul_f32 v[142:143], v[142:143], v[172:173]
    v_pk_mul_f32 v[144:145], v[144:145], v[174:175]
    v_pk_mul_f32 v[146:147], v[146:147], v[176:177]
    v_pk_mul_f32 v[148:149], v[148:149], v[178:179]
    v_pk_mul_f32 v[150:151], v[150:151], v[180:181]
    v_pk_mul_f32 v[152:153], v[152:153], v[182:183]
    v_pk_mul_f32 v[154:155], v[154:155], v[184:185]
    v_cvt_pk_bf16_f32 v68, v154, v152
    v_cvt_pk_bf16_f32 v69, v150, v148
    v_cvt_pk_bf16_f32 v70, v146, v144
    v_cvt_pk_bf16_f32 v71, v142, v140
    ds_write_b128 v235, v[68:71] offset:8192
    v_cvt_pk_bf16_f32 v72, v155, v153
    v_cvt_pk_bf16_f32 v73, v151, v149
    v_cvt_pk_bf16_f32 v74, v147, v145
    v_cvt_pk_bf16_f32 v75, v143, v141
    ds_write_b128 v235, v[72:75] offset:8320
    s_waitcnt lgkmcnt(0)
    s_barrier
    ds_read_b128 v[68:71], v236 offset:8192
    ds_read_b128 v[72:75], v237 offset:9216
    s_lshr_b32 s4, s64, 1
    s_and_b32 s5, s64, 1
    s_mul_i32 s6, s4, 18560
    s_mul_i32 s7, s5, 2048
    s_add_u32 s6, s6, s7
    s_add_u32 s6, s6, 384
    v_add_u32 v239, s6, v14
    s_mul_i32 s6, s64, 9280
    v_lshrrev_b32 v35, 5, v0
    v_mul_u32_u24 v35, 4640, v35
    v_min_u32 v255, 92, v31
    v_lshl_add_u32 v255, v255, 2, v35
    v_add_u32 v255, s6, v255
    s_waitcnt vmcnt(17)
    v_lshlrev_b32 v224, 16, v112
    v_lshlrev_b32 v225, 16, v114
    v_and_b32 v226, 0xffff0000, v112
    v_and_b32 v227, 0xffff0000, v114
    v_lshlrev_b32 v228, 16, v113
    v_lshlrev_b32 v229, 16, v115
    v_and_b32 v230, 0xffff0000, v113
    v_and_b32 v231, 0xffff0000, v115
    v_lshlrev_b32 v170, 16, v92
    v_and_b32 v171, 0xffff0000, v92
    v_lshlrev_b32 v172, 16, v93
    v_and_b32 v173, 0xffff0000, v93
    v_lshlrev_b32 v174, 16, v94
    v_and_b32 v175, 0xffff0000, v94
    v_lshlrev_b32 v176, 16, v95
    v_and_b32 v177, 0xffff0000, v95
    v_lshlrev_b32 v178, 16, v96
    v_and_b32 v179, 0xffff0000, v96
    v_lshlrev_b32 v180, 16, v97
    v_and_b32 v181, 0xffff0000, v97
    v_lshlrev_b32 v182, 16, v98
    v_and_b32 v183, 0xffff0000, v98
    s_waitcnt lgkmcnt(1)
    buffer_store_dwordx4 v[68:71], v6, s[56:59], s97 offen sc1
    v_lshlrev_b32 v184, 16, v99
    v_and_b32 v185, 0xffff0000, v99
    v_lshlrev_b32 v186, 16, v100
    v_and_b32 v187, 0xffff0000, v100
    v_lshlrev_b32 v188, 16, v101
    v_and_b32 v189, 0xffff0000, v101
    v_lshlrev_b32 v190, 16, v102
    v_and_b32 v191, 0xffff0000, v102
    v_pk_mul_f32 v[140:141], v[176:177], v[224:225]
    v_pk_mul_f32 v[142:143], v[178:179], v[224:225]
    v_pk_mul_f32 v[144:145], v[180:181], v[224:225]
    v_pk_mul_f32 v[146:147], v[182:183], v[224:225]
    v_pk_mul_f32 v[148:149], v[184:185], v[224:225]
    v_pk_mul_f32 v[150:151], v[186:187], v[224:225]
    v_pk_mul_f32 v[152:153], v[188:189], v[224:225]
    v_pk_mul_f32 v[154:155], v[190:191], v[224:225]
    v_pk_fma_f32 v[140:141], v[174:175], v[226:227], v[140:141]
    v_pk_fma_f32 v[142:143], v[176:177], v[226:227], v[142:143]
    v_pk_fma_f32 v[144:145], v[178:179], v[226:227], v[144:145]
    v_pk_fma_f32 v[146:147], v[180:181], v[226:227], v[146:147]
    v_pk_fma_f32 v[148:149], v[182:183], v[226:227], v[148:149]
    s_add_u32 s97, s97, 33792
    s_waitcnt lgkmcnt(0)
    buffer_store_dwordx4 v[72:75], v6, s[56:59], s97 offen sc1
    v_pk_fma_f32 v[150:151], v[184:185], v[226:227], v[150:151]
    v_pk_fma_f32 v[152:153], v[186:187], v[226:227], v[152:153]
    v_pk_fma_f32 v[154:155], v[188:189], v[226:227], v[154:155]
    v_pk_fma_f32 v[140:141], v[172:173], v[228:229], v[140:141]
    v_pk_fma_f32 v[142:143], v[174:175], v[228:229], v[142:143]
    v_pk_fma_f32 v[144:145], v[176:177], v[228:229], v[144:145]
    v_pk_fma_f32 v[146:147], v[178:179], v[228:229], v[146:147]
    v_pk_fma_f32 v[148:149], v[180:181], v[228:229], v[148:149]
    v_pk_fma_f32 v[150:151], v[182:183], v[228:229], v[150:151]
    v_pk_fma_f32 v[152:153], v[184:185], v[228:229], v[152:153]
    v_pk_fma_f32 v[154:155], v[186:187], v[228:229], v[154:155]
    v_pk_fma_f32 v[140:141], v[170:171], v[230:231], v[140:141]
    v_pk_fma_f32 v[142:143], v[172:173], v[230:231], v[142:143]
    v_pk_fma_f32 v[144:145], v[174:175], v[230:231], v[144:145]
    v_pk_fma_f32 v[146:147], v[176:177], v[230:231], v[146:147]
    v_pk_fma_f32 v[148:149], v[178:179], v[230:231], v[148:149]
    v_pk_fma_f32 v[150:151], v[180:181], v[230:231], v[150:151]
    v_pk_fma_f32 v[152:153], v[182:183], v[230:231], v[152:153]
    v_pk_fma_f32 v[154:155], v[184:185], v[230:231], v[154:155]
    s_waitcnt vmcnt(11)
    v_lshlrev_b32 v170, 16, v103
    v_and_b32 v171, 0xffff0000, v103
    v_lshlrev_b32 v172, 16, v104
    v_and_b32 v173, 0xffff0000, v104
    v_lshlrev_b32 v174, 16, v105
    v_and_b32 v175, 0xffff0000, v105
    v_lshlrev_b32 v176, 16, v106
    v_and_b32 v177, 0xffff0000, v106
    v_lshlrev_b32 v178, 16, v107
    v_and_b32 v179, 0xffff0000, v107
    v_lshlrev_b32 v180, 16, v108
    v_and_b32 v181, 0xffff0000, v108
    v_lshlrev_b32 v182, 16, v109
    v_and_b32 v183, 0xffff0000, v109
    v_lshlrev_b32 v184, 16, v110
    v_and_b32 v185, 0xffff0000, v110
    v_pk_mul_f32 v[140:141], v[140:141], v[170:171]
    v_pk_mul_f32 v[142:143], v[142:143], v[172:173]
    v_pk_mul_f32 v[144:145], v[144:145], v[174:175]
    v_pk_mul_f32 v[146:147], v[146:147], v[176:177]
    v_pk_mul_f32 v[148:149], v[148:149], v[178:179]
    v_pk_mul_f32 v[150:151], v[150:151], v[180:181]
    v_pk_mul_f32 v[152:153], v[152:153], v[182:183]
    v_pk_mul_f32 v[154:155], v[154:155], v[184:185]
    v_cvt_pk_bf16_f32 v92, v154, v152
    v_cvt_pk_bf16_f32 v93, v150, v148
    v_cvt_pk_bf16_f32 v94, v146, v144
    v_cvt_pk_bf16_f32 v95, v142, v140
    ds_write_b128 v235, v[92:95] offset:16384
    v_cvt_pk_bf16_f32 v96, v155, v153
    v_cvt_pk_bf16_f32 v97, v151, v149
    v_cvt_pk_bf16_f32 v98, v147, v145
    v_cvt_pk_bf16_f32 v99, v143, v141
    ds_write_b128 v235, v[96:99] offset:16512
    s_waitcnt vmcnt(6) lgkmcnt(0)
    s_barrier
    ds_read_b128 v[92:95], v236 offset:16384
    ds_read_b128 v[96:99], v237 offset:17408
    s_waitcnt lgkmcnt(1)
    buffer_store_dwordx4 v[92:95], v6, s[56:59], s98 offen sc1
    s_add_u32 s98, s98, 33792
    s_waitcnt lgkmcnt(0)
    buffer_store_dwordx4 v[96:99], v6, s[56:59], s98 offen sc1
    v_lshrrev_b32 v33, 2, v0
    v_mul_u32_u24 v33, 96, v33
    v_bfe_u32 v34, v0, 3, 2
    v_lshl_add_u32 v33, v34, 5, v33
    v_add_u32 v33, v33, v16
    s_mul_i32 s4, s64, 160
    s_lshr_b32 s5, s4, 7
    s_mul_i32 s5, s5, 3968
    s_add_u32 s5, s5, s4
    v_xor_b32 v34, s5, v33
    v_add_u32 v34, 136704, v34
    ds_read_b64_tr_b16 a[0:1], v34 offset:0
    ds_read_b64_tr_b16 a[2:3], v34 offset:2048
    s_add_u32 s4, s4, 32
    s_lshr_b32 s5, s4, 7
    s_mul_i32 s5, s5, 3968
    s_add_u32 s5, s5, s4
    v_xor_b32 v34, s5, v33
    v_add_u32 v34, 136704, v34
    ds_read_b64_tr_b16 a[4:5], v34 offset:0
    ds_read_b64_tr_b16 a[6:7], v34 offset:2048
    s_add_u32 s4, s4, 32
    s_lshr_b32 s5, s4, 7
    s_mul_i32 s5, s5, 3968
    s_add_u32 s5, s5, s4
    v_xor_b32 v34, s5, v33
    v_add_u32 v34, 136704, v34
    ds_read_b64_tr_b16 a[8:9], v34 offset:0
    ds_read_b64_tr_b16 a[10:11], v34 offset:2048
L_st6:
    s_cbranch_execz L_wb_F
    s_add_u32 s4, s4, 32
    s_lshr_b32 s5, s4, 7
    s_mul_i32 s5, s5, 3968
    s_add_u32 s5, s5, s4
    v_xor_b32 v34, s5, v33
    v_add_u32 v34, 136704, v34
    ds_read_b64_tr_b16 a[12:13], v34 offset:0
    ds_read_b64_tr_b16 a[14:15], v34 offset:2048
    s_add_u32 s4, s4, 32
    s_lshr_b32 s5, s4, 7
    s_mul_i32 s5, s5, 3968
    s_add_u32 s5, s5, s4
    v_xor_b32 v34, s5, v33
    v_add_u32 v34, 136704, v34
    ds_read_b64_tr_b16 a[16:17], v34 offset:0
    ds_read_b64_tr_b16 a[18:19], v34 offset:2048
    v_lshrrev_b32 v34, 4, v0
    v_bfe_u32 v33, v0, 2, 2
    v_lshl_add_u32 v33, v34, 3, v33
    v_and_b32 v35, 24, v16
    v_lshl_add_u32 v33, v33, 7, v35
    v_bfe_u32 v35, v0, 3, 2
    v_xor_b32 v35, s64, v35
    v_lshl_add_u32 v33, v35, 5, v33
    v_add_u32 v33, 91136, v33
    ds_read_b64_tr_b16 a[32:33], v33 offset:0
    ds_read_b64_tr_b16 a[34:35], v33 offset:512
    ds_read_b64_tr_b16 a[36:37], v33 offset:4096
    ds_read_b64_tr_b16 a[38:39], v33 offset:4608
    ds_read_b64_tr_b16 a[40:41], v33 offset:8192
    ds_read_b64_tr_b16 a[42:43], v33 offset:8704
    ds_read_b64_tr_b16 a[44:45], v33 offset:12288
    ds_read_b64_tr_b16 a[46:47], v33 offset:12800
    ds_read_b64_tr_b16 a[48:49], v33 offset:16384
    ds_read_b64_tr_b16 a[50:51], v33 offset:16896
    v_mov_b32 v36, 0x3f803f80
    v_mov_b32 v37, 0x3f803f80
    v_mov_b32 v38, 0x3f803f80
    v_mov_b32 v39, 0x3f803f80
    v_min_u32 v33, 1, v28
    v_and_b32 v34, 48, v0
    v_lshl_or_b32 v11, v33, 31, v34
    s_waitcnt lgkmcnt(8)
    v_mfma_f32_16x16x32_bf16 v[40:43], a[32:35], v[36:39], 0
    s_waitcnt lgkmcnt(6)
    v_mfma_f32_16x16x32_bf16 v[40:43], a[36:39], v[36:39], v[40:43]
    s_waitcnt lgkmcnt(4)
    v_mfma_f32_16x16x32_bf16 v[40:43], a[40:43], v[36:39], v[40:43]
    s_waitcnt lgkmcnt(2)
    v_mfma_f32_16x16x32_bf16 v[40:43], a[44:47], v[36:39], v[40:43]
    s_waitcnt lgkmcnt(0)
    v_mfma_f32_16x16x32_bf16 v[40:43], a[48:51], v[36:39], v[40:43]
    s_waitcnt lgkmcnt(0)
    s_waitcnt vmcnt(0)
    s_barrier
    buffer_store_dword v19, v17, s[56:59], s9 offen sc1
    buffer_store_dwordx4 a[0:3], v8, s[56:59], s99 offen offset:0 sc1
    buffer_store_dwordx4 a[4:7], v8, s[56:59], s99 offen offset:1024 sc1
    buffer_store_dwordx4 a[8:11], v8, s[56:59], s99 offen offset:2048 sc1
    buffer_store_dwordx4 a[12:15], v8, s[56:59], s99 offen offset:3072 sc1
    s_add_u32 s99, s99, 4096
    buffer_store_dwordx4 a[16:19], v8, s[56:59], s99 offen offset:0 sc1
    buffer_store_dwordx4 v[40:43], v11, s[56:59], s91 offen sc1
    s_add_u32 s89, s89, 8192
    buffer_load_dwordx4 v[216:219], v14, s[48:51], s89 offen nt
    buffer_load_dwordx4 v[220:223], v14, s[48:51], s89 offen offset:1024 nt
    s_add_u32 s89, s89, 8192
    buffer_load_dwordx4 v[244:247], v14, s[48:51], s89 offen nt
    buffer_load_dwordx4 v[248:251], v14, s[48:51], s89 offen offset:1024 nt
    v_lshrrev_b32 v33, 5, v0
    v_mul_u32_u24 v33, 4224, v33
    v_add_u32 v33, v33, v31
    v_mov_b32 v34, 0
    v_add_u32 v33, 41216, v33
    ds_write_b32 v33, v34
    v_add_u32 v33, 45568, v33
    ds_write_b32 v33, v34
    v_add_u32 v33, 45568, v33
    ds_write_b32 v33, v34
    s_and_b32 s78, s67, 3
    s_mul_i32 s7, s69, 4
    s_add_u32 s78, s78, s7
    s_mul_i32 s23, s78, 276480
    s_mul_i32 s7, s64, 71680
    s_add_u32 s23, s23, s7
    s_add_u32 s23, s23, 5619712
    s_lshr_b32 s4, s64, 1
    s_and_b32 s5, s64, 1
    s_mul_i32 s12, s3, 64
    s_add_u32 s12, s12, 65536
    s_mul_i32 s6, s4, 18560
    s_mul_i32 s7, s5, 256
    s_add_u32 s6, s6, s7
    v_and_b32 v2, 3, v0
    v_mul_u32_u24 v1, 4640, v2
    v_bfe_u32 v2, v0, 2, 2
    v_lshl_add_u32 v1, v2, 7, v1
    v_and_b32 v3, 48, v0
    v_add3_u32 v1, v1, v3, s6
    s_mul_i32 s6, s4, 4224
    s_mul_i32 s7, s5, 256
    s_add_u32 s6, s6, s7
    s_add_u32 s6, s6, 37240
    v_and_b32 v2, 0x78, v16
    v_sub_u32 v2, v3, v2
    v_add_u32 v2, s6, v2
    s_mul_i32 s88, s4, 4224
    s_mul_i32 s7, s5, 2048
    s_add_u32 s88, s88, s7
    s_mul_i32 s87, s79, 8448
    s_add_u32 s87, s87, s88
    s_add_u32 s87, s87, 212992
    s_add_u32 s90, s87, 2703360
    s_mul_i32 s6, s64, 4096
    s_add_u32 s6, s6, 136704
    v_add_u32 v3, s6, v14
    s_xor_b32 s6, s64, 1
    s_mul_i32 s6, s6, 4096
    s_add_u32 s6, s6, 136704
    v_add_u32 v4, s6, v14
    s_add_u32 s4, s9, 40960
    s_waitcnt vmcnt(4)
    s_barrier
    buffer_store_dword v19, v17, s[56:59], s4 offen sc1
    s_cmp_ge_u32 s2, 251
    s_cbranch_scc1 L_roleR
    v_add_u32 v33, 0, v239
    v_add_u32 v34, 0, v255
    v_mov_b32 v56, 0
    v_mov_b32 v57, 0
    v_mov_b32 v58, 0
    v_mov_b32 v59, 0
    ds_write_b128 v34, v[56:59]
    v_mov_b32 v35, 0
    v_writelane_b32 v35, s17, 0
    v_mov_b32 v200, s72
    v_mov_b32 v201, s73
    v_mov_b32_dpp v202, v206 wave_ror:1 row_mask:0xf bank_mask:0xf
    v_mov_b32_dpp v203, v207 wave_ror:1 row_mask:0xf bank_mask:0xf
    v_mov_b32_dpp v200, v206 wave_shr:1 row_mask:0xf bank_mask:0xf
    v_mov_b32_dpp v201, v207 wave_shr:1 row_mask:0xf bank_mask:0xf
    v_mov_b32_dpp v202, v210 wave_shr:1 row_mask:0xf bank_mask:0xf
    v_mov_b32_dpp v203, v211 wave_shr:1 row_mask:0xf bank_mask:0xf
    v_lshlrev_b32 v34, 16, v204
    v_add_f32 v34, v34, v35
    v_and_b32 v35, 0xffff0000, v204
    v_cvt_pk_bf16_f32 v204, v34, v35
    ds_write_b128 v33, v[204:207] offset:13920
    v_alignbit_b32 v44, v201, v200, 16
    v_alignbit_b32 v45, v204, v201, 16
    v_alignbit_b32 v46, v205, v204, 16
    v_alignbit_b32 v47, v206, v205, 16
    ds_write_b128 v33, v[44:47] offset:0
    v_mov_b32 v48, v201
    v_mov_b32 v49, v204
    v_mov_b32 v50, v205
    v_mov_b32 v51, v206
    ds_write_b128 v33, v[48:51] offset:4640
    v_alignbit_b32 v52, v204, v201, 16
    v_alignbit_b32 v53, v205, v204, 16
    v_alignbit_b32 v54, v206, v205, 16
    v_alignbit_b32 v55, v207, v206, 16
    ds_write_b128 v33, v[52:55] offset:9280
    ds_write_b128 v33, v[208:211] offset:14944
    v_alignbit_b32 v44, v203, v202, 16
    v_alignbit_b32 v45, v208, v203, 16
    v_alignbit_b32 v46, v209, v208, 16
    v_alignbit_b32 v47, v210, v209, 16
    ds_write_b128 v33, v[44:47] offset:1024
    v_mov_b32 v48, v203
    v_mov_b32 v49, v208
    v_mov_b32 v50, v209
    v_mov_b32 v51, v210
    ds_write_b128 v33, v[48:51] offset:5664
    v_alignbit_b32 v52, v208, v203, 16
    v_alignbit_b32 v53, v209, v208, 16
    v_alignbit_b32 v54, v210, v209, 16
    v_alignbit_b32 v55, v211, v210, 16
    ds_write_b128 v33, v[52:55] offset:10304
    v_add_u32 v33, 45568, v239
    v_add_u32 v34, 45568, v255
    v_mov_b32 v56, 0
    v_mov_b32 v57, 0
    v_mov_b32 v58, 0
    v_mov_b32 v59, 0
    ds_write_b128 v34, v[56:59]
    v_mov_b32 v35, 0
    v_writelane_b32 v35, s18, 0
    v_mov_b32 v212, s74
    v_mov_b32 v213, s75
    s_waitcnt vmcnt(3)
    v_mov_b32_dpp v214, v218 wave_ror:1 row_mask:0xf bank_mask:0xf
    v_mov_b32_dpp v215, v219 wave_ror:1 row_mask:0xf bank_mask:0xf
    v_mov_b32_dpp v212, v218 wave_shr:1 row_mask:0xf bank_mask:0xf
    v_mov_b32_dpp v213, v219 wave_shr:1 row_mask:0xf bank_mask:0xf
    v_mov_b32_dpp v214, v222 wave_shr:1 row_mask:0xf bank_mask:0xf
    v_mov_b32_dpp v215, v223 wave_shr:1 row_mask:0xf bank_mask:0xf
    v_lshlrev_b32 v34, 16, v216
    v_add_f32 v34, v34, v35
    v_and_b32 v35, 0xffff0000, v216
    v_cvt_pk_bf16_f32 v216, v34, v35
    ds_write_b128 v33, v[216:219] offset:13920
    v_alignbit_b32 v44, v213, v212, 16
    v_alignbit_b32 v45, v216, v213, 16
    v_alignbit_b32 v46, v217, v216, 16
    v_alignbit_b32 v47, v218, v217, 16
    ds_write_b128 v33, v[44:47] offset:0
    v_mov_b32 v48, v213
    v_mov_b32 v49, v216
    v_mov_b32 v50, v217
    v_mov_b32 v51, v218
    ds_write_b128 v33, v[48:51] offset:4640
    v_alignbit_b32 v52, v216, v213, 16
    v_alignbit_b32 v53, v217, v216, 16
    v_alignbit_b32 v54, v218, v217, 16
    v_alignbit_b32 v55, v219, v218, 16
    ds_write_b128 v33, v[52:55] offset:9280
    ds_write_b128 v33, v[220:223] offset:14944
    v_alignbit_b32 v44, v215, v214, 16
    v_alignbit_b32 v45, v220, v215, 16
    v_alignbit_b32 v46, v221, v220, 16
    v_alignbit_b32 v47, v222, v221, 16
    ds_write_b128 v33, v[44:47] offset:1024
    v_mov_b32 v48, v215
    v_mov_b32 v49, v220
    v_mov_b32 v50, v221
    v_mov_b32 v51, v222
    ds_write_b128 v33, v[48:51] offset:5664
    v_alignbit_b32 v52, v220, v215, 16
    v_alignbit_b32 v53, v221, v220, 16
    v_alignbit_b32 v54, v222, v221, 16
    v_alignbit_b32 v55, v223, v222, 16
    ds_write_b128 v33, v[52:55] offset:10304
    s_mul_i32 s4, s64, 1792
    s_add_u32 s4, s4, 8192
    v_min_u32 v5, 27, v0
    v_lshl_add_u32 v5, v5, 6, s4
    buffer_load_dword v9, v5, s[56:59], 0 offen sc1
    v_add_u32 v33, 91136, v239
    v_add_u32 v34, 91136, v255
    v_mov_b32 v56, 0
    v_mov_b32 v57, 0
    v_mov_b32 v58, 0
    v_mov_b32 v59, 0
    ds_write_b128 v34, v[56:59]
    v_mov_b32 v35, 0
    v_writelane_b32 v35, s19, 0
    v_mov_b32 v240, s82
    v_mov_b32 v241, s83
    s_waitcnt vmcnt(2)
    v_mov_b32_dpp v242, v246 wave_ror:1 row_mask:0xf bank_mask:0xf
    v_mov_b32_dpp v243, v247 wave_ror:1 row_mask:0xf bank_mask:0xf
    v_mov_b32_dpp v240, v246 wave_shr:1 row_mask:0xf bank_mask:0xf
    v_mov_b32_dpp v241, v247 wave_shr:1 row_mask:0xf bank_mask:0xf
    v_mov_b32_dpp v242, v250 wave_shr:1 row_mask:0xf bank_mask:0xf
    v_mov_b32_dpp v243, v251 wave_shr:1 row_mask:0xf bank_mask:0xf
    v_lshlrev_b32 v34, 16, v244
    v_add_f32 v34, v34, v35
    v_and_b32 v35, 0xffff0000, v244
    v_cvt_pk_bf16_f32 v244, v34, v35
    ds_write_b128 v33, v[244:247] offset:13920
    v_alignbit_b32 v44, v241, v240, 16
    v_alignbit_b32 v45, v244, v241, 16
    v_alignbit_b32 v46, v245, v244, 16
    v_alignbit_b32 v47, v246, v245, 16
    ds_write_b128 v33, v[44:47] offset:0
    v_mov_b32 v48, v241
    v_mov_b32 v49, v244
    v_mov_b32 v50, v245
    v_mov_b32 v51, v246
    ds_write_b128 v33, v[48:51] offset:4640
    v_alignbit_b32 v52, v244, v241, 16
    v_alignbit_b32 v53, v245, v244, 16
    v_alignbit_b32 v54, v246, v245, 16
    v_alignbit_b32 v55, v247, v246, 16
    ds_write_b128 v33, v[52:55] offset:9280
    ds_write_b128 v33, v[248:251] offset:14944
    v_alignbit_b32 v44, v243, v242, 16
    v_alignbit_b32 v45, v248, v243, 16
    v_alignbit_b32 v46, v249, v248, 16
    v_alignbit_b32 v47, v250, v249, 16
    ds_write_b128 v33, v[44:47] offset:1024
    v_mov_b32 v48, v243
    v_mov_b32 v49, v248
    v_mov_b32 v50, v249
    v_mov_b32 v51, v250
    ds_write_b128 v33, v[48:51] offset:5664
    v_alignbit_b32 v52, v248, v243, 16
    v_alignbit_b32 v53, v249, v248, 16
    v_alignbit_b32 v54, v250, v249, 16
    v_alignbit_b32 v55, v251, v250, 16
    ds_write_b128 v33, v[52:55] offset:10304
    s_waitcnt vmcnt(0)
    v_cmp_ne_u32 vcc, s65, v9
    s_cbranch_vccnz L_spin11
L_ok12:
    s_barrier
    s_add_u32 m0, s88, 37120
    s_nop 0
    buffer_load_dwordx4 v14, s[56:59], s87 offen sc1 nt lds
    buffer_load_dwordx4 v14, s[56:59], s87 offen offset:1024 sc1 nt lds
    s_add_u32 s87, s87, 8448
    s_add_u32 m0, s88, 82688
    s_nop 0
    buffer_load_dwordx4 v14, s[56:59], s87 offen sc1 nt lds
    buffer_load_dwordx4 v14, s[56:59], s87 offen offset:1024 sc1 nt lds
    s_add_u32 s87, s87, 8448
    s_add_u32 m0, s88, 128256
    s_nop 0
    buffer_load_dwordx4 v14, s[56:59], s87 offen sc1 nt lds
    buffer_load_dwordx4 v14, s[56:59], s87 offen offset:1024 sc1 nt lds
    s_mul_i32 s4, s64, 1792
    s_add_u32 s4, s4, 49152
    v_min_u32 v10, 27, v0
    v_lshl_add_u32 v10, v10, 6, s4
    buffer_load_dword v12, v10, s[56:59], 0 offen sc1
    s_lshr_b32 s77, s67, 2
    s_mul_i32 s7, s68, 8
    s_add_u32 s77, s77, s7
    s_mul_i32 s93, s64, 3072
    s_mul_i32 s6, s77, 81920
    s_mul_i32 s7, s64, 20480
    s_add_u32 s6, s6, s7
    s_mul_i32 s7, s78, 160
    s_add_u32 s6, s6, s7
    v_add_u32 v33, 0, v0
    v_mul_u32_u24 v35, 6554, v33
    v_lshrrev_b32 v35, 16, v35
    v_mul_u32_u24 v35, 1120, v35
    v_lshl_add_u32 v35, v33, 4, v35
    v_add_u32 v24, s6, v35
    v_add_u32 v33, 64, v0
    v_mul_u32_u24 v35, 6554, v33
    v_lshrrev_b32 v35, 16, v35
    v_mul_u32_u24 v35, 1120, v35
    v_lshl_add_u32 v35, v33, 4, v35
    v_add_u32 v25, s6, v35
    v_add_u32 v33, 128, v0
    v_mul_u32_u24 v35, 6554, v33
    v_lshrrev_b32 v35, 16, v35
    v_mul_u32_u24 v35, 1120, v35
    v_lshl_add_u32 v35, v33, 4, v35
    v_add_u32 v26, s6, v35
    v_lshrrev_b32 v33, 5, v0
    v_lshl_or_b32 v26, v33, 31, v26
    v_and_b32 v33, 15, v0
    v_lshrrev_b32 v34, 4, v0
    s_lshr_b32 s4, s64, 1
    s_and_b32 s6, s4, s64
    v_lshl_or_b32 v15, s6, 31, v14
    s_mul_i32 s6, s78, 427
    s_lshr_b32 s6, s6, 5
    v_min_u32 v29, 13, v0
    v_add_u32 v29, s6, v29
    v_min_u32 v29, 106, v29
    v_lshlrev_b32 v29, 6, v29
    s_mov_b32 s21, 65536
    s_lshr_b32 s6, s77, 1
    s_mul_i32 s20, s6, 1024
    s_add_u32 s20, s20, 32768
    s_mul_i32 s6, s64, 19
    s_lshr_b32 s6, s6, 3
    v_min_u32 v30, 2, v0
    v_add_u32 v30, s6, v30
    v_min_u32 v30, 8, v30
    v_lshlrev_b32 v30, 6, v30
    s_mul_i32 s4, s77, 229376
    s_mul_i32 s7, s64, 14336
    s_add_u32 s4, s4, s7
    s_add_u32 s4, s4, 7831552
    s_add_u32 s6, s64, 1
    s_and_b32 s6, s6, 3
    s_mul_i32 s84, s6, 15360
    s_add_u32 s84, s84, 12288
    s_mul_i32 s24, s6, 57344
    s_add_u32 s24, s24, s4
    s_add_u32 s6, s64, 2
    s_and_b32 s6, s6, 3
    s_mul_i32 s85, s6, 15360
    s_add_u32 s85, s85, 17408
    s_mul_i32 s25, s6, 57344
    s_add_u32 s25, s25, s4
    s_add_u32 s6, s64, 3
    s_and_b32 s6, s6, 3
    s_mul_i32 s86, s6, 15360
    s_add_u32 s86, s86, 22528
    s_mul_i32 s26, s6, 57344
    s_add_u32 s26, s26, s4
    s_add_u32 s6, s64, 4
    s_and_b32 s6, s6, 3
    s_mul_i32 s27, s6, 57344
    s_add_u32 s27, s27, s4
    s_mul_i32 s6, s64, 15360
    s_add_u32 s6, s6, 12288
    v_add_u32 v20, s6, v14
    v_add_u32 v23, s93, v14
    v_mul_u32_u24 v21, 160, v33
    v_lshl_add_u32 v21, v34, 3, v21
    v_add_u32 v21, s93, v21
    s_lshr_b32 s6, s64, 1
    s_mul_i32 s6, s6, -120
    s_mul_i32 s7, s64, 64
    s_add_u32 s6, s6, s7
    s_add_u32 s6, s6, 73728
    v_lshrrev_b32 v35, 2, v0
    v_lshlrev_b32 v35, 6, v35
    v_add3_u32 v22, v35, v14, s6
    v_and_b32 v35, 64, v16
    v_xor_b32 v22, v35, v22
    v_and_b32 v35, 64, v31
    v_xor_b32 v27, v35, v27
    s_mul_i32 s94, s64, 1024
    s_add_u32 s94, s94, 73728
    s_mul_i32 s95, s78, 337920
    s_mul_i32 s7, s64, 33792
    s_add_u32 s95, s95, s7
    s_mul_i32 s7, s77, 128
    s_add_u32 s95, s95, s7
    s_add_u32 s95, s95, 2916352
    s_mul_i32 s6, s77, 4
    s_add_u32 s6, s6, s64
    s_lshr_b32 s92, s6, 3
    s_mul_i32 s92, s92, 992
    s_mul_i32 s7, s6, 4
    s_add_u32 s92, s92, s7
    s_add_u32 s92, s92, 16384
    s_lshr_b32 s4, s64, 1
    s_and_b32 s5, s64, 1
    s_mul_i32 s70, s4, 27008
    s_mul_i32 s7, s5, 18304
    s_add_u32 s70, s70, s7
    s_add_u32 s70, s70, 45568
    s_mul_i32 s71, s4, 41344
    s_mul_i32 s7, s5, 3968
    s_add_u32 s71, s71, s7
    s_add_u32 s71, s71, 45568
    s_mul_i32 s76, s79, 8448
    s_mul_i32 s7, s64, 4224
    s_add_u32 s76, s76, s7
    s_add_u32 s76, s76, 2924800
    v_mov_b32 v18, v17
    v_bfe_u32 v33, v0, 3, 1
    v_mul_u32_u24 v33, 384, v33
    v_and_b32 v34, 48, v0
    v_lshlrev_b32 v34, 3, v34
    v_sub_u32 v33, v33, v34
    v_add_u32 v13, v33, v14
    s_waitcnt vmcnt(5) lgkmcnt(0)
    s_barrier
    ds_read_b64 v[168:169], v2 offset:3584
    ds_read_b64 v[170:171], v2 offset:3592
    ds_read_b128 v[136:139], v1 offset:0
    ds_read_b64 v[172:173], v2 offset:3072
    ds_read_b64 v[174:175], v2 offset:3080
    ds_read_b128 v[140:143], v1 offset:512
    ds_read_b64 v[176:177], v2 offset:2560
    ds_read_b64 v[178:179], v2 offset:2568
    ds_read_b128 v[144:147], v1 offset:1024
    ds_read_b64 v[180:181], v2 offset:2048
    ds_read_b64 v[182:183], v2 offset:2056
    ds_read_b128 v[148:151], v1 offset:1536
    ds_read_b64 v[184:185], v2 offset:1536
    ds_read_b64 v[186:187], v2 offset:1544
    ds_read_b128 v[152:155], v1 offset:2048
    ds_read_b64 v[188:189], v2 offset:1024
    ds_read_b64 v[190:191], v2 offset:1032
    ds_read_b128 v[156:159], v1 offset:2560
    ds_read_b64 v[192:193], v2 offset:512
    ds_read_b64 v[194:195], v2 offset:520
    ds_read_b128 v[160:163], v1 offset:3072
    ds_read_b64 v[196:197], v2 offset:0
    ds_read_b64 v[198:199], v2 offset:8
    ds_read_b128 v[164:167], v1 offset:3584
    s_waitcnt lgkmcnt(15)
    v_mfma_f32_16x16x32_bf16 v[232:235], v[136:139], v[168:171], 0
    s_waitcnt lgkmcnt(15)
    v_mfma_f32_16x16x32_bf16 v[236:239], v[136:139], v[172:175], 0
    s_waitcnt lgkmcnt(15)
    v_mfma_f32_16x16x32_bf16 v[236:239], v[140:143], v[168:171], v[236:239]
    s_waitcnt lgkmcnt(15)
    v_mfma_f32_16x16x32_bf16 v[240:243], v[144:147], v[168:171], 0
    v_mfma_f32_16x16x32_bf16 v[240:243], v[140:143], v[172:175], v[240:243]
    v_mfma_f32_16x16x32_bf16 v[240:243], v[136:139], v[176:179], v[240:243]
    s_waitcnt lgkmcnt(13)
    v_mfma_f32_16x16x32_bf16 v[244:247], v[136:139], v[180:183], 0
    ds_read_b64 v[200:201], v2 offset:3648
    v_mfma_f32_16x16x32_bf16 v[244:247], v[140:143], v[176:179], v[244:247]
    ds_read_b64 v[202:203], v2 offset:3656
    v_mfma_f32_16x16x32_bf16 v[244:247], v[144:147], v[172:175], v[244:247]
    ds_read_b128 v[76:79], v1 offset:64
    s_waitcnt lgkmcnt(15)
    v_mfma_f32_16x16x32_bf16 v[244:247], v[148:151], v[168:171], v[244:247]
    ds_read_b64 v[204:205], v2 offset:3136
    s_waitcnt lgkmcnt(13)
    v_mfma_f32_16x16x32_bf16 v[248:251], v[152:155], v[168:171], 0
    s_waitcnt vmcnt(0)
    v_cmp_ne_u32 vcc, s65, v12
    s_cbranch_vccnz L_spin9
L_ok10:
    s_barrier
    v_mfma_f32_16x16x32_bf16 v[248:251], v[148:151], v[172:175], v[248:251]
    ds_read_b64 v[206:207], v2 offset:3144
    ds_read_b128 v[80:83], v1 offset:576
    v_mfma_f32_16x16x32_bf16 v[248:251], v[144:147], v[176:179], v[248:251]
    s_add_u32 s23, s23, 28672
    v_mfma_f32_16x16x32_bf16 v[248:251], v[140:143], v[180:183], v[248:251]
    ds_read_b64 v[208:209], v2 offset:2624
    buffer_load_dwordx4 a[112:115], v14, s[56:59], s23 offen offset:0 sc1
    v_mfma_f32_16x16x32_bf16 v[248:251], v[136:139], v[184:187], v[248:251]
    ds_read_b64 v[210:211], v2 offset:2632
    s_waitcnt lgkmcnt(15)
    v_mfma_f32_16x16x32_bf16 v[252:255], v[136:139], v[188:191], 0
    ds_read_b128 v[84:87], v1 offset:1088
    v_mfma_f32_16x16x32_bf16 v[252:255], v[140:143], v[184:187], v[252:255]
    ds_read_b64 v[212:213], v2 offset:2112
    v_mfma_f32_16x16x32_bf16 v[252:255], v[144:147], v[180:183], v[252:255]
    ds_read_b64 v[214:215], v2 offset:2120
    buffer_load_dwordx4 a[116:119], v14, s[56:59], s23 offen offset:1024 sc1
    v_mfma_f32_16x16x32_bf16 v[252:255], v[148:151], v[176:179], v[252:255]
    ds_read_b128 v[88:91], v1 offset:1600
    v_mfma_f32_16x16x32_bf16 v[252:255], v[152:155], v[172:175], v[252:255]
    s_waitcnt lgkmcnt(15)
    v_mfma_f32_16x16x32_bf16 v[252:255], v[156:159], v[168:171], v[252:255]
    ds_read_b64 v[216:217], v2 offset:1600
    s_waitcnt lgkmcnt(15)
    v_mfma_f32_16x16x32_bf16 v[36:39], v[160:163], v[168:171], 0
    ds_read_b64 v[218:219], v2 offset:1608
    v_mfma_f32_16x16x32_bf16 v[36:39], v[156:159], v[172:175], v[36:39]
    ds_read_b128 v[92:95], v1 offset:2112
    buffer_load_dwordx4 a[120:123], v14, s[56:59], s23 offen offset:2048 sc1
    v_mfma_f32_16x16x32_bf16 v[36:39], v[152:155], v[176:179], v[36:39]
    ds_read_b64 v[220:221], v2 offset:1088
    v_mfma_f32_16x16x32_bf16 v[36:39], v[148:151], v[180:183], v[36:39]
    ds_read_b64 v[222:223], v2 offset:1096
    v_mfma_f32_16x16x32_bf16 v[36:39], v[144:147], v[184:187], v[36:39]
    ds_read_b128 v[96:99], v1 offset:2624
    v_mfma_f32_16x16x32_bf16 v[36:39], v[140:143], v[188:191], v[36:39]
    buffer_load_dwordx4 a[124:127], v14, s[56:59], s23 offen offset:3072 sc1
    v_mfma_f32_16x16x32_bf16 v[36:39], v[136:139], v[192:195], v[36:39]
    ds_read_b64 v[224:225], v2 offset:576
    s_waitcnt lgkmcnt(15)
    v_mfma_f32_16x16x32_bf16 v[40:43], v[136:139], v[196:199], 0
    ds_read_b64 v[226:227], v2 offset:584
    v_mfma_f32_16x16x32_bf16 v[40:43], v[140:143], v[192:195], v[40:43]
    ds_read_b128 v[100:103], v1 offset:3136
    v_mfma_f32_16x16x32_bf16 v[40:43], v[144:147], v[188:191], v[40:43]
    ds_read_b64 v[228:229], v2 offset:64
    s_add_u32 s23, s23, 4096
    v_mfma_f32_16x16x32_bf16 v[40:43], v[148:151], v[184:187], v[40:43]
    ds_read_b64 v[230:231], v2 offset:72
    buffer_load_dwordx4 a[128:131], v14, s[56:59], s23 offen offset:0 sc1
    v_mfma_f32_16x16x32_bf16 v[40:43], v[152:155], v[180:183], v[40:43]
    ds_read_b128 v[104:107], v1 offset:3648
    v_mfma_f32_16x16x32_bf16 v[40:43], v[156:159], v[176:179], v[40:43]
    v_mfma_f32_16x16x32_bf16 v[40:43], v[160:163], v[172:175], v[40:43]
    s_waitcnt lgkmcnt(15)
    v_mfma_f32_16x16x32_bf16 v[40:43], v[164:167], v[168:171], v[40:43]
    buffer_load_dwordx4 a[132:135], v14, s[56:59], s23 offen offset:1024 sc1
    s_waitcnt lgkmcnt(0)
    v_mfma_f32_16x16x32_bf16 v[232:235], v[76:79], v[200:203], v[232:235]
    ds_read_b64 v[168:169], v2 offset:3712
    v_mfma_f32_16x16x32_bf16 v[236:239], v[76:79], v[204:207], v[236:239]
    ds_read_b64 v[170:171], v2 offset:3720
    v_mfma_f32_16x16x32_bf16 v[236:239], v[80:83], v[200:203], v[236:239]
    ds_read_b128 v[136:139], v1 offset:128
    v_mfma_f32_16x16x32_bf16 v[240:243], v[84:87], v[200:203], v[240:243]
    ds_read_b64 v[172:173], v2 offset:3200
    v_mfma_f32_16x16x32_bf16 v[240:243], v[80:83], v[204:207], v[240:243]
    buffer_load_dwordx4 a[136:139], v14, s[56:59], s23 offen offset:2048 sc1
    v_mfma_f32_16x16x32_bf16 v[240:243], v[76:79], v[208:211], v[240:243]
    ds_read_b64 v[174:175], v2 offset:3208
    v_mfma_f32_16x16x32_bf16 v[244:247], v[76:79], v[212:215], v[244:247]
    ds_read_b128 v[140:143], v1 offset:640
    v_mfma_f32_16x16x32_bf16 v[244:247], v[80:83], v[208:211], v[244:247]
    ds_read_b64 v[176:177], v2 offset:2688
    v_mfma_f32_16x16x32_bf16 v[244:247], v[84:87], v[204:207], v[244:247]
    buffer_load_dwordx4 a[140:143], v14, s[56:59], s23 offen offset:3072 sc1
    v_mfma_f32_16x16x32_bf16 v[244:247], v[88:91], v[200:203], v[244:247]
    ds_read_b64 v[178:179], v2 offset:2696
    v_mfma_f32_16x16x32_bf16 v[248:251], v[92:95], v[200:203], v[248:251]
    ds_read_b128 v[144:147], v1 offset:1152
    v_mfma_f32_16x16x32_bf16 v[248:251], v[88:91], v[204:207], v[248:251]
    ds_read_b64 v[180:181], v2 offset:2176
    v_mfma_f32_16x16x32_bf16 v[248:251], v[84:87], v[208:211], v[248:251]
    ds_read_b64 v[182:183], v2 offset:2184
    s_add_u32 s23, s23, 4096
    v_mfma_f32_16x16x32_bf16 v[248:251], v[80:83], v[212:215], v[248:251]
    buffer_load_dwordx4 a[144:147], v14, s[56:59], s23 offen offset:0 sc1
    v_mfma_f32_16x16x32_bf16 v[248:251], v[76:79], v[216:219], v[248:251]
    ds_read_b128 v[148:151], v1 offset:1664
    v_mfma_f32_16x16x32_bf16 v[252:255], v[76:79], v[220:223], v[252:255]
    ds_read_b64 v[184:185], v2 offset:1664
    v_mfma_f32_16x16x32_bf16 v[252:255], v[80:83], v[216:219], v[252:255]
    ds_read_b64 v[186:187], v2 offset:1672
    v_mfma_f32_16x16x32_bf16 v[252:255], v[84:87], v[212:215], v[252:255]
    buffer_load_dwordx4 a[148:151], v14, s[56:59], s23 offen offset:1024 sc1
    v_mfma_f32_16x16x32_bf16 v[252:255], v[88:91], v[208:211], v[252:255]
    ds_read_b128 v[152:155], v1 offset:2176
    v_mfma_f32_16x16x32_bf16 v[252:255], v[92:95], v[204:207], v[252:255]
    ds_read_b64 v[188:189], v2 offset:1152
    v_mfma_f32_16x16x32_bf16 v[252:255], v[96:99], v[200:203], v[252:255]
    ds_read_b64 v[190:191], v2 offset:1160
    v_mfma_f32_16x16x32_bf16 v[36:39], v[100:103], v[200:203], v[36:39]
    ds_read_b128 v[156:159], v1 offset:2688
    v_mfma_f32_16x16x32_bf16 v[36:39], v[96:99], v[204:207], v[36:39]
    buffer_load_dwordx4 a[152:155], v14, s[56:59], s23 offen offset:2048 sc1
    v_mfma_f32_16x16x32_bf16 v[36:39], v[92:95], v[208:211], v[36:39]
    ds_read_b64 v[192:193], v2 offset:640
    v_mfma_f32_16x16x32_bf16 v[36:39], v[88:91], v[212:215], v[36:39]
    ds_read_b64 v[194:195], v2 offset:648
    v_mfma_f32_16x16x32_bf16 v[36:39], v[84:87], v[216:219], v[36:39]
    ds_read_b128 v[160:163], v1 offset:3200
    v_mfma_f32_16x16x32_bf16 v[36:39], v[80:83], v[220:223], v[36:39]
L_st7:
    s_cbranch_execz L_wb_F
    buffer_load_dwordx4 a[156:159], v14, s[56:59], s23 offen offset:3072 sc1
    v_mfma_f32_16x16x32_bf16 v[36:39], v[76:79], v[224:227], v[36:39]
    ds_read_b64 v[196:197], v2 offset:128
    v_mfma_f32_16x16x32_bf16 v[40:43], v[76:79], v[228:231], v[40:43]
    ds_read_b64 v[198:199], v2 offset:136
    v_mfma_f32_16x16x32_bf16 v[40:43], v[80:83], v[224:227], v[40:43]
    ds_read_b128 v[164:167], v1 offset:3712
    v_mfma_f32_16x16x32_bf16 v[40:43], v[84:87], v[220:223], v[40:43]
    s_add_u32 s23, s23, 4096
    v_mfma_f32_16x16x32_bf16 v[40:43], v[88:91], v[216:219], v[40:43]
    buffer_load_dwordx4 a[160:163], v14, s[56:59], s23 offen offset:0 sc1
    v_mfma_f32_16x16x32_bf16 v[40:43], v[92:95], v[212:215], v[40:43]
    v_mfma_f32_16x16x32_bf16 v[40:43], v[96:99], v[208:211], v[40:43]
    v_mfma_f32_16x16x32_bf16 v[40:43], v[100:103], v[204:207], v[40:43]
    v_mfma_f32_16x16x32_bf16 v[40:43], v[104:107], v[200:203], v[40:43]
    buffer_load_dwordx4 a[164:167], v14, s[56:59], s23 offen offset:1024 sc1
    s_waitcnt lgkmcnt(0)
    v_mfma_f32_16x16x32_bf16 v[232:235], v[136:139], v[168:171], v[232:235]
    ds_read_b64 v[200:201], v2 offset:3776
    v_mfma_f32_16x16x32_bf16 v[236:239], v[136:139], v[172:175], v[236:239]
    ds_read_b64 v[202:203], v2 offset:3784
    v_mfma_f32_16x16x32_bf16 v[236:239], v[140:143], v[168:171], v[236:239]
    ds_read_b128 v[76:79], v1 offset:192
    v_mfma_f32_16x16x32_bf16 v[240:243], v[144:147], v[168:171], v[240:243]
    ds_read_b64 v[204:205], v2 offset:3264
    v_mfma_f32_16x16x32_bf16 v[240:243], v[140:143], v[172:175], v[240:243]
    buffer_load_dwordx4 a[168:171], v14, s[56:59], s23 offen offset:2048 sc1
    v_mfma_f32_16x16x32_bf16 v[240:243], v[136:139], v[176:179], v[240:243]
    ds_read_b64 v[206:207], v2 offset:3272
    v_mfma_f32_16x16x32_bf16 v[244:247], v[136:139], v[180:183], v[244:247]
    ds_read_b128 v[80:83], v1 offset:704
    v_mfma_f32_16x16x32_bf16 v[244:247], v[140:143], v[176:179], v[244:247]
    ds_read_b64 v[208:209], v2 offset:2752
    v_mfma_f32_16x16x32_bf16 v[244:247], v[144:147], v[172:175], v[244:247]
    buffer_load_dwordx4 a[172:175], v14, s[56:59], s23 offen offset:3072 sc1
    v_mfma_f32_16x16x32_bf16 v[244:247], v[148:151], v[168:171], v[244:247]
    ds_read_b64 v[210:211], v2 offset:2760
    v_mfma_f32_16x16x32_bf16 v[248:251], v[152:155], v[168:171], v[248:251]
    ds_read_b128 v[84:87], v1 offset:1216
    v_mfma_f32_16x16x32_bf16 v[248:251], v[148:151], v[172:175], v[248:251]
    ds_read_b64 v[212:213], v2 offset:2240
    v_mfma_f32_16x16x32_bf16 v[248:251], v[144:147], v[176:179], v[248:251]
    ds_read_b64 v[214:215], v2 offset:2248
    s_add_u32 s23, s23, 4096
    v_mfma_f32_16x16x32_bf16 v[248:251], v[140:143], v[180:183], v[248:251]
    buffer_load_dwordx4 a[176:179], v14, s[56:59], s23 offen offset:0 sc1
    v_mfma_f32_16x16x32_bf16 v[248:251], v[136:139], v[184:187], v[248:251]
    ds_read_b128 v[88:91], v1 offset:1728
    v_mfma_f32_16x16x32_bf16 v[252:255], v[136:139], v[188:191], v[252:255]
    ds_read_b64 v[216:217], v2 offset:1728
    v_mfma_f32_16x16x32_bf16 v[252:255], v[140:143], v[184:187], v[252:255]
    ds_read_b64 v[218:219], v2 offset:1736
    v_mfma_f32_16x16x32_bf16 v[252:255], v[144:147], v[180:183], v[252:255]
    buffer_load_dwordx4 a[180:183], v14, s[56:59], s23 offen offset:1024 sc1
    v_mfma_f32_16x16x32_bf16 v[252:255], v[148:151], v[176:179], v[252:255]
    ds_read_b128 v[92:95], v1 offset:2240
    v_mfma_f32_16x16x32_bf16 v[252:255], v[152:155], v[172:175], v[252:255]
    ds_read_b64 v[220:221], v2 offset:1216
    v_mfma_f32_16x16x32_bf16 v[252:255], v[156:159], v[168:171], v[252:255]
    ds_read_b64 v[222:223], v2 offset:1224
    v_mfma_f32_16x16x32_bf16 v[36:39], v[160:163], v[168:171], v[36:39]
    ds_read_b128 v[96:99], v1 offset:2752
    v_mfma_f32_16x16x32_bf16 v[36:39], v[156:159], v[172:175], v[36:39]
    buffer_load_dwordx4 a[184:187], v14, s[56:59], s23 offen offset:2048 sc1
    v_mfma_f32_16x16x32_bf16 v[36:39], v[152:155], v[176:179], v[36:39]
    ds_read_b64 v[224:225], v2 offset:704
    v_mfma_f32_16x16x32_bf16 v[36:39], v[148:151], v[180:183], v[36:39]
    ds_read_b64 v[226:227], v2 offset:712
    v_mfma_f32_16x16x32_bf16 v[36:39], v[144:147], v[184:187], v[36:39]
    ds_read_b128 v[100:103], v1 offset:3264
    v_mfma_f32_16x16x32_bf16 v[36:39], v[140:143], v[188:191], v[36:39]
    buffer_load_dwordx4 a[188:191], v14, s[56:59], s23 offen offset:3072 sc1
    v_mfma_f32_16x16x32_bf16 v[36:39], v[136:139], v[192:195], v[36:39]
    ds_read_b64 v[228:229], v2 offset:192
    v_mfma_f32_16x16x32_bf16 v[40:43], v[136:139], v[196:199], v[40:43]
    ds_read_b64 v[230:231], v2 offset:200
    v_mfma_f32_16x16x32_bf16 v[40:43], v[140:143], v[192:195], v[40:43]
    ds_read_b128 v[104:107], v1 offset:3776
    v_mfma_f32_16x16x32_bf16 v[40:43], v[144:147], v[188:191], v[40:43]
    s_add_u32 s23, s23, 4096
    v_mfma_f32_16x16x32_bf16 v[40:43], v[148:151], v[184:187], v[40:43]
    buffer_load_dwordx4 a[192:195], v14, s[56:59], s23 offen offset:0 sc1
    v_mfma_f32_16x16x32_bf16 v[40:43], v[152:155], v[180:183], v[40:43]
    v_mfma_f32_16x16x32_bf16 v[40:43], v[156:159], v[176:179], v[40:43]
    v_mfma_f32_16x16x32_bf16 v[40:43], v[160:163], v[172:175], v[40:43]
    v_mfma_f32_16x16x32_bf16 v[40:43], v[164:167], v[168:171], v[40:43]
    buffer_load_dwordx4 a[196:199], v14, s[56:59], s23 offen offset:1024 sc1
    s_waitcnt lgkmcnt(0)
    v_mfma_f32_16x16x32_bf16 v[232:235], v[76:79], v[200:203], v[232:235]
    v_add_u32 v1, s70, v1
    v_add_u32 v2, s71, v2
    ds_read_b64 v[168:169], v2 offset:3584
    v_mfma_f32_16x16x32_bf16 v[236:239], v[76:79], v[204:207], v[236:239]
    ds_read_b64 v[170:171], v2 offset:3592
    v_mfma_f32_16x16x32_bf16 v[236:239], v[80:83], v[200:203], v[236:239]
    ds_read_b128 v[136:139], v1 offset:0
    v_mfma_f32_16x16x32_bf16 v[240:243], v[84:87], v[200:203], v[240:243]
    ds_read_b64 v[172:173], v2 offset:3072
    v_mfma_f32_16x16x32_bf16 v[240:243], v[80:83], v[204:207], v[240:243]
    buffer_load_dwordx4 a[200:203], v14, s[56:59], s23 offen offset:2048 sc1
    v_mfma_f32_16x16x32_bf16 v[240:243], v[76:79], v[208:211], v[240:243]
    ds_read_b64 v[174:175], v2 offset:3080
    v_mfma_f32_16x16x32_bf16 v[244:247], v[76:79], v[212:215], v[244:247]
    ds_read_b128 v[140:143], v1 offset:512
    v_mfma_f32_16x16x32_bf16 v[244:247], v[80:83], v[208:211], v[244:247]
    ds_read_b64 v[176:177], v2 offset:2560
    v_mfma_f32_16x16x32_bf16 v[244:247], v[84:87], v[204:207], v[244:247]
    buffer_load_dwordx4 a[204:207], v14, s[56:59], s23 offen offset:3072 sc1
    v_mfma_f32_16x16x32_bf16 v[244:247], v[88:91], v[200:203], v[244:247]
    ds_read_b64 v[178:179], v2 offset:2568
    v_mfma_f32_16x16x32_bf16 v[248:251], v[92:95], v[200:203], v[248:251]
    ds_read_b128 v[144:147], v1 offset:1024
    v_mfma_f32_16x16x32_bf16 v[248:251], v[88:91], v[204:207], v[248:251]
    ds_read_b64 v[180:181], v2 offset:2048
    v_mfma_f32_16x16x32_bf16 v[248:251], v[84:87], v[208:211], v[248:251]
    ds_read_b64 v[182:183], v2 offset:2056
    s_add_u32 s23, s23, 4096
    v_mfma_f32_16x16x32_bf16 v[248:251], v[80:83], v[212:215], v[248:251]
    buffer_load_dwordx4 a[208:211], v14, s[56:59], s23 offen offset:0 sc1
    v_mfma_f32_16x16x32_bf16 v[248:251], v[76:79], v[216:219], v[248:251]
    ds_read_b128 v[148:151], v1 offset:1536
    v_mfma_f32_16x16x32_bf16 v[252:255], v[76:79], v[220:223], v[252:255]
    ds_read_b64 v[184:185], v2 offset:1536
    v_mfma_f32_16x16x32_bf16 v[252:255], v[80:83], v[216:219], v[252:255]
    ds_read_b64 v[186:187], v2 offset:1544
    v_mfma_f32_16x16x32_bf16 v[252:255], v[84:87], v[212:215], v[252:255]
    buffer_load_dwordx4 a[212:215], v14, s[56:59], s23 offen offset:1024 sc1
    v_mfma_f32_16x16x32_bf16 v[252:255], v[88:91], v[208:211], v[252:255]
    ds_read_b128 v[152:155], v1 offset:2048
    v_mfma_f32_16x16x32_bf16 v[252:255], v[92:95], v[204:207], v[252:255]
    ds_read_b64 v[188:189], v2 offset:1024
    v_mfma_f32_16x16x32_bf16 v[252:255], v[96:99], v[200:203], v[252:255]
    ds_read_b64 v[190:191], v2 offset:1032
    v_mfma_f32_16x16x32_bf16 v[36:39], v[100:103], v[200:203], v[36:39]
    ds_read_b128 v[156:159], v1 offset:2560
    v_mfma_f32_16x16x32_bf16 v[36:39], v[96:99], v[204:207], v[36:39]
    buffer_load_dwordx4 a[216:219], v14, s[56:59], s23 offen offset:2048 sc1
    v_mfma_f32_16x16x32_bf16 v[36:39], v[92:95], v[208:211], v[36:39]
    ds_read_b64 v[192:193], v2 offset:512
    v_mfma_f32_16x16x32_bf16 v[36:39], v[88:91], v[212:215], v[36:39]
    ds_read_b64 v[194:195], v2 offset:520
    v_mfma_f32_16x16x32_bf16 v[36:39], v[84:87], v[216:219], v[36:39]
    ds_read_b128 v[160:163], v1 offset:3072
    v_mfma_f32_16x16x32_bf16 v[36:39], v[80:83], v[220:223], v[36:39]
    buffer_load_dwordx4 a[220:223], v14, s[56:59], s23 offen offset:3072 sc1
    v_mfma_f32_16x16x32_bf16 v[36:39], v[76:79], v[224:227], v[36:39]
    ds_read_b64 v[196:197], v2 offset:0
    v_mfma_f32_16x16x32_bf16 v[40:43], v[76:79], v[228:231], v[40:43]
    ds_read_b64 v[198:199], v2 offset:8
    v_mfma_f32_16x16x32_bf16 v[40:43], v[80:83], v[224:227], v[40:43]
    ds_read_b128 v[164:167], v1 offset:3584
    v_mfma_f32_16x16x32_bf16 v[40:43], v[84:87], v[220:223], v[40:43]
    s_add_u32 s23, s23, 4096
    v_mfma_f32_16x16x32_bf16 v[40:43], v[88:91], v[216:219], v[40:43]
    buffer_load_dwordx4 a[224:227], v14, s[56:59], s23 offen offset:0 sc1
    v_mfma_f32_16x16x32_bf16 v[40:43], v[92:95], v[212:215], v[40:43]
    v_mfma_f32_16x16x32_bf16 v[40:43], v[96:99], v[208:211], v[40:43]
    v_mfma_f32_16x16x32_bf16 v[40:43], v[100:103], v[204:207], v[40:43]
    v_mfma_f32_16x16x32_bf16 v[40:43], v[104:107], v[200:203], v[40:43]
    s_waitcnt lgkmcnt(0)
    v_mfma_f32_16x16x32_bf16 v[44:47], v[136:139], v[168:171], 0
    ds_read_b64 v[200:201], v2 offset:3648
    v_mfma_f32_16x16x32_bf16 v[48:51], v[136:139], v[172:175], 0
    ds_read_b64 v[202:203], v2 offset:3656
    v_mfma_f32_16x16x32_bf16 v[48:51], v[140:143], v[168:171], v[48:51]
    ds_read_b128 v[76:79], v1 offset:64
    v_mfma_f32_16x16x32_bf16 v[52:55], v[144:147], v[168:171], 0
    ds_read_b64 v[204:205], v2 offset:3136
    v_mfma_f32_16x16x32_bf16 v[52:55], v[140:143], v[172:175], v[52:55]
    ds_read_b64 v[206:207], v2 offset:3144
    v_cndmask_b32 v108, v248, v232, s[80:81]
    v_cndmask_b32 v109, v249, v233, s[80:81]
    v_mfma_f32_16x16x32_bf16 v[52:55], v[136:139], v[176:179], v[52:55]
    ds_read_b128 v[80:83], v1 offset:576
    v_cndmask_b32 v110, v250, v234, s[80:81]
    v_cndmask_b32 v111, v251, v235, s[80:81]
    v_mfma_f32_16x16x32_bf16 v[56:59], v[136:139], v[180:183], 0
    ds_write_b128 v3, v[108:111] offset:0
    v_mfma_f32_16x16x32_bf16 v[56:59], v[140:143], v[176:179], v[56:59]
    ds_read_b64 v[208:209], v2 offset:2624
    v_cndmask_b32 v112, v252, v236, s[80:81]
    v_mfma_f32_16x16x32_bf16 v[56:59], v[144:147], v[172:175], v[56:59]
    ds_read_b64 v[210:211], v2 offset:2632
    v_cndmask_b32 v113, v253, v237, s[80:81]
    v_cndmask_b32 v114, v254, v238, s[80:81]
    v_mfma_f32_16x16x32_bf16 v[56:59], v[148:151], v[168:171], v[56:59]
    ds_read_b128 v[84:87], v1 offset:1088
    v_cndmask_b32 v115, v255, v239, s[80:81]
    v_mfma_f32_16x16x32_bf16 v[60:63], v[152:155], v[168:171], 0
    ds_write_b128 v3, v[112:115] offset:1024
    v_mfma_f32_16x16x32_bf16 v[60:63], v[148:151], v[172:175], v[60:63]
    ds_read_b64 v[212:213], v2 offset:2112
    v_cndmask_b32 v116, v36, v240, s[80:81]
    v_mfma_f32_16x16x32_bf16 v[60:63], v[144:147], v[176:179], v[60:63]
    ds_read_b64 v[214:215], v2 offset:2120
    v_cndmask_b32 v117, v37, v241, s[80:81]
    v_cndmask_b32 v118, v38, v242, s[80:81]
    v_mfma_f32_16x16x32_bf16 v[60:63], v[140:143], v[180:183], v[60:63]
    ds_read_b128 v[88:91], v1 offset:1600
    v_cndmask_b32 v119, v39, v243, s[80:81]
    v_mfma_f32_16x16x32_bf16 v[60:63], v[136:139], v[184:187], v[60:63]
    ds_write_b128 v3, v[116:119] offset:2048
    v_mfma_f32_16x16x32_bf16 v[64:67], v[136:139], v[188:191], 0
    ds_read_b64 v[216:217], v2 offset:1600
    v_cndmask_b32 v120, v40, v244, s[80:81]
    v_mfma_f32_16x16x32_bf16 v[64:67], v[140:143], v[184:187], v[64:67]
    ds_read_b64 v[218:219], v2 offset:1608
    v_cndmask_b32 v121, v41, v245, s[80:81]
    v_cndmask_b32 v122, v42, v246, s[80:81]
    v_mfma_f32_16x16x32_bf16 v[64:67], v[144:147], v[180:183], v[64:67]
    ds_read_b128 v[92:95], v1 offset:2112
    v_cndmask_b32 v123, v43, v247, s[80:81]
    v_mfma_f32_16x16x32_bf16 v[64:67], v[148:151], v[176:179], v[64:67]
    ds_write_b128 v3, v[120:123] offset:3072
    v_mfma_f32_16x16x32_bf16 v[64:67], v[152:155], v[172:175], v[64:67]
    ds_read_b64 v[220:221], v2 offset:1088
    v_cndmask_b32 v232, v232, v248, s[80:81]
    v_cndmask_b32 v233, v233, v249, s[80:81]
    v_mfma_f32_16x16x32_bf16 v[64:67], v[156:159], v[168:171], v[64:67]
    ds_read_b64 v[222:223], v2 offset:1096
    v_cndmask_b32 v234, v234, v250, s[80:81]
    v_cndmask_b32 v235, v235, v251, s[80:81]
    v_mfma_f32_16x16x32_bf16 v[68:71], v[160:163], v[168:171], 0
    ds_read_b128 v[96:99], v1 offset:2624
    v_cndmask_b32 v236, v236, v252, s[80:81]
    v_mfma_f32_16x16x32_bf16 v[68:71], v[156:159], v[172:175], v[68:71]
    ds_read_b64 v[224:225], v2 offset:576
    v_cndmask_b32 v237, v237, v253, s[80:81]
    v_cndmask_b32 v238, v238, v254, s[80:81]
    v_mfma_f32_16x16x32_bf16 v[68:71], v[152:155], v[176:179], v[68:71]
    ds_read_b64 v[226:227], v2 offset:584
    v_cndmask_b32 v239, v239, v255, s[80:81]
    v_cndmask_b32 v240, v240, v36, s[80:81]
    v_mfma_f32_16x16x32_bf16 v[68:71], v[148:151], v[180:183], v[68:71]
    ds_read_b128 v[100:103], v1 offset:3136
    v_cndmask_b32 v241, v241, v37, s[80:81]
    v_cndmask_b32 v242, v242, v38, s[80:81]
    v_mfma_f32_16x16x32_bf16 v[68:71], v[144:147], v[184:187], v[68:71]
    ds_read_b64 v[228:229], v2 offset:64
    v_cndmask_b32 v243, v243, v39, s[80:81]
    v_cndmask_b32 v244, v244, v40, s[80:81]
    v_mfma_f32_16x16x32_bf16 v[68:71], v[140:143], v[188:191], v[68:71]
    ds_read_b64 v[230:231], v2 offset:72
    v_cndmask_b32 v245, v245, v41, s[80:81]
    v_cndmask_b32 v246, v246, v42, s[80:81]
    v_mfma_f32_16x16x32_bf16 v[68:71], v[136:139], v[192:195], v[68:71]
    ds_read_b128 v[104:107], v1 offset:3648
    v_cndmask_b32 v247, v247, v43, s[80:81]
    v_mfma_f32_16x16x32_bf16 v[72:75], v[136:139], v[196:199], 0
    v_mfma_f32_16x16x32_bf16 v[72:75], v[140:143], v[192:195], v[72:75]
    v_mfma_f32_16x16x32_bf16 v[72:75], v[144:147], v[188:191], v[72:75]
    v_mfma_f32_16x16x32_bf16 v[72:75], v[148:151], v[184:187], v[72:75]
    v_mfma_f32_16x16x32_bf16 v[72:75], v[152:155], v[180:183], v[72:75]
    s_waitcnt lgkmcnt(9)
    s_barrier
    v_mfma_f32_16x16x32_bf16 v[72:75], v[156:159], v[176:179], v[72:75]
    buffer_load_dwordx4 a[228:231], v14, s[56:59], s23 offen offset:1024 sc1
    v_mfma_f32_16x16x32_bf16 v[72:75], v[160:163], v[172:175], v[72:75]
    ds_read_b128 v[108:111], v4 offset:0
    v_mfma_f32_16x16x32_bf16 v[72:75], v[164:167], v[168:171], v[72:75]
    ds_read_b128 v[112:115], v4 offset:1024
    s_waitcnt lgkmcnt(2)
    v_mfma_f32_16x16x32_bf16 v[44:47], v[76:79], v[200:203], v[44:47]
    ds_read_b64 v[168:169], v2 offset:3712
    ds_read_b128 v[116:119], v4 offset:2048
    v_mfma_f32_16x16x32_bf16 v[48:51], v[76:79], v[204:207], v[48:51]
    ds_read_b64 v[170:171], v2 offset:3720
    buffer_load_dwordx4 a[232:235], v14, s[56:59], s23 offen offset:2048 sc1
    v_mfma_f32_16x16x32_bf16 v[48:51], v[80:83], v[200:203], v[48:51]
    ds_read_b128 v[136:139], v1 offset:128
    ds_read_b128 v[120:123], v4 offset:3072
    v_mfma_f32_16x16x32_bf16 v[52:55], v[84:87], v[200:203], v[52:55]
    v_mfma_f32_16x16x32_bf16 v[52:55], v[80:83], v[204:207], v[52:55]
    ds_read_b64 v[172:173], v2 offset:3200
    v_mfma_f32_16x16x32_bf16 v[52:55], v[76:79], v[208:211], v[52:55]
    ds_read_b64 v[174:175], v2 offset:3208
    buffer_load_dwordx4 a[236:239], v14, s[56:59], s23 offen offset:3072 sc1
    v_mfma_f32_16x16x32_bf16 v[56:59], v[76:79], v[212:215], v[56:59]
    v_mfma_f32_16x16x32_bf16 v[56:59], v[80:83], v[208:211], v[56:59]
    ds_read_b128 v[140:143], v1 offset:640
    v_mfma_f32_16x16x32_bf16 v[56:59], v[84:87], v[204:207], v[56:59]
    ds_read_b64 v[176:177], v2 offset:2688
    s_add_u32 s23, s23, 4096
    v_mfma_f32_16x16x32_bf16 v[56:59], v[88:91], v[200:203], v[56:59]
    ds_read_b64 v[178:179], v2 offset:2696
    buffer_load_dwordx4 a[240:243], v15, s[56:59], s23 offen offset:0 sc1
    v_mfma_f32_16x16x32_bf16 v[60:63], v[92:95], v[200:203], v[60:63]
    s_waitcnt lgkmcnt(11)
    v_add_f32 v232, v232, v108
    v_add_f32 v233, v233, v109
    v_mfma_f32_16x16x32_bf16 v[60:63], v[88:91], v[204:207], v[60:63]
    ds_read_b128 v[144:147], v1 offset:1152
    v_add_f32 v234, v234, v110
    v_add_f32 v235, v235, v111
    v_mfma_f32_16x16x32_bf16 v[60:63], v[84:87], v[208:211], v[60:63]
    ds_read_b64 v[180:181], v2 offset:2176
    s_waitcnt lgkmcnt(12)
    v_add_f32 v236, v236, v112
    v_add_f32 v237, v237, v113
    v_mfma_f32_16x16x32_bf16 v[60:63], v[80:83], v[212:215], v[60:63]
    v_add_f32 v238, v238, v114
    v_add_f32 v239, v239, v115
    buffer_load_dwordx4 a[244:247], v15, s[56:59], s23 offen offset:1024 sc1
    v_mfma_f32_16x16x32_bf16 v[60:63], v[76:79], v[216:219], v[60:63]
    ds_read_b64 v[182:183], v2 offset:2184
    v_cvt_pk_bf16_f32 v124, v232, v233
    v_cvt_pk_bf16_f32 v125, v234, v235
    v_mfma_f32_16x16x32_bf16 v[64:67], v[76:79], v[220:223], v[64:67]
    ds_read_b128 v[148:151], v1 offset:1664
    v_cvt_pk_bf16_f32 v132, v236, v237
    v_cvt_pk_bf16_f32 v133, v238, v239
    v_mfma_f32_16x16x32_bf16 v[64:67], v[80:83], v[216:219], v[64:67]
    v_cvt_pk_bf16_f32 v126, v236, v237
    v_cvt_pk_bf16_f32 v127, v238, v239
    s_nop 0
    v_mfma_f32_16x16x32_bf16 v[64:67], v[84:87], v[212:215], v[64:67]
    ds_read_b64 v[184:185], v2 offset:1664
    v_mov_b32_dpp v126, v124 row_ror:8 row_mask:0xf bank_mask:0x3
    v_mov_b32_dpp v127, v125 row_ror:8 row_mask:0xf bank_mask:0x3
    v_mfma_f32_16x16x32_bf16 v[64:67], v[88:91], v[208:211], v[64:67]
    ds_read_b64 v[186:187], v2 offset:1672
    v_mov_b32_dpp v124, v132 row_ror:8 row_mask:0xf bank_mask:0xc
    v_mov_b32_dpp v125, v133 row_ror:8 row_mask:0xf bank_mask:0xc
    buffer_load_dwordx4 a[248:251], v15, s[56:59], s23 offen offset:2048 sc1
    v_mfma_f32_16x16x32_bf16 v[64:67], v[92:95], v[204:207], v[64:67]
    ds_read_b128 v[152:155], v1 offset:2176
    buffer_store_dwordx4 v[124:127], v13, s[56:59], s90 offen offset:0 sc1
    v_mfma_f32_16x16x32_bf16 v[64:67], v[96:99], v[200:203], v[64:67]
    s_waitcnt lgkmcnt(15)
    v_add_f32 v240, v240, v116
    v_add_f32 v241, v241, v117
    v_mfma_f32_16x16x32_bf16 v[68:71], v[100:103], v[200:203], v[68:71]
    ds_read_b64 v[188:189], v2 offset:1152
    v_add_f32 v242, v242, v118
    v_add_f32 v243, v243, v119
    v_mfma_f32_16x16x32_bf16 v[68:71], v[96:99], v[204:207], v[68:71]
    ds_read_b64 v[190:191], v2 offset:1160
    s_waitcnt lgkmcnt(14)
    v_add_f32 v244, v244, v120
    buffer_load_dwordx4 a[252:255], v15, s[56:59], s23 offen offset:3072 sc1
    v_mfma_f32_16x16x32_bf16 v[68:71], v[92:95], v[208:211], v[68:71]
    v_add_f32 v245, v245, v121
    v_add_f32 v246, v246, v122
    v_mfma_f32_16x16x32_bf16 v[68:71], v[88:91], v[212:215], v[68:71]
    ds_read_b128 v[156:159], v1 offset:2688
    v_add_f32 v247, v247, v123
    v_cvt_pk_bf16_f32 v128, v240, v241
    v_mfma_f32_16x16x32_bf16 v[68:71], v[84:87], v[216:219], v[68:71]
    ds_read_b64 v[192:193], v2 offset:640
    v_cvt_pk_bf16_f32 v129, v242, v243
    v_cvt_pk_bf16_f32 v132, v244, v245
    s_add_u32 s23, s23, 4294905856
    v_mfma_f32_16x16x32_bf16 v[68:71], v[80:83], v[220:223], v[68:71]
    ds_read_b64 v[194:195], v2 offset:648
    v_cvt_pk_bf16_f32 v133, v246, v247
    v_cvt_pk_bf16_f32 v130, v244, v245
    buffer_load_dwordx4 a[0:3], v14, s[56:59], s23 offen offset:0 sc1
    v_mfma_f32_16x16x32_bf16 v[68:71], v[76:79], v[224:227], v[68:71]
    v_cvt_pk_bf16_f32 v131, v246, v247
    s_nop 0
    v_mov_b32_dpp v130, v128 row_ror:8 row_mask:0xf bank_mask:0x3
    v_mfma_f32_16x16x32_bf16 v[72:75], v[76:79], v[228:231], v[72:75]
    ds_read_b128 v[160:163], v1 offset:3200
    v_mov_b32_dpp v131, v129 row_ror:8 row_mask:0xf bank_mask:0x3
    v_mov_b32_dpp v128, v132 row_ror:8 row_mask:0xf bank_mask:0xc
    v_mfma_f32_16x16x32_bf16 v[72:75], v[80:83], v[224:227], v[72:75]
    ds_read_b64 v[196:197], v2 offset:128
    v_mov_b32_dpp v129, v133 row_ror:8 row_mask:0xf bank_mask:0xc
    v_mfma_f32_16x16x32_bf16 v[72:75], v[84:87], v[220:223], v[72:75]
    buffer_load_dwordx4 a[4:7], v14, s[56:59], s23 offen offset:1024 sc1
    v_mfma_f32_16x16x32_bf16 v[72:75], v[88:91], v[216:219], v[72:75]
    ds_read_b64 v[198:199], v2 offset:136
    buffer_store_dwordx4 v[128:131], v13, s[56:59], s90 offen offset:1024 sc1
    v_mfma_f32_16x16x32_bf16 v[72:75], v[92:95], v[212:215], v[72:75]
    ds_read_b128 v[164:167], v1 offset:3712
    s_mov_b32 s90, s76
    v_mfma_f32_16x16x32_bf16 v[72:75], v[96:99], v[208:211], v[72:75]
    v_mfma_f32_16x16x32_bf16 v[72:75], v[100:103], v[204:207], v[72:75]
    buffer_load_dwordx4 a[8:11], v14, s[56:59], s23 offen offset:2048 sc1
    v_mfma_f32_16x16x32_bf16 v[72:75], v[104:107], v[200:203], v[72:75]
    s_waitcnt lgkmcnt(0)
    v_mfma_f32_16x16x32_bf16 v[44:47], v[136:139], v[168:171], v[44:47]
    ds_read_b64 v[200:201], v2 offset:3776
    v_mfma_f32_16x16x32_bf16 v[48:51], v[136:139], v[172:175], v[48:51]
    ds_read_b64 v[202:203], v2 offset:3784
    v_mfma_f32_16x16x32_bf16 v[48:51], v[140:143], v[168:171], v[48:51]
    buffer_load_dwordx4 a[12:15], v14, s[56:59], s23 offen offset:3072 sc1
    v_mfma_f32_16x16x32_bf16 v[52:55], v[144:147], v[168:171], v[52:55]
    ds_read_b128 v[76:79], v1 offset:192
    v_mfma_f32_16x16x32_bf16 v[52:55], v[140:143], v[172:175], v[52:55]
    ds_read_b64 v[204:205], v2 offset:3264
    v_mfma_f32_16x16x32_bf16 v[52:55], v[136:139], v[176:179], v[52:55]
    ds_read_b64 v[206:207], v2 offset:3272
    v_mfma_f32_16x16x32_bf16 v[56:59], v[136:139], v[180:183], v[56:59]
    ds_read_b128 v[80:83], v1 offset:704
    s_add_u32 s23, s23, 4096
    v_mfma_f32_16x16x32_bf16 v[56:59], v[140:143], v[176:179], v[56:59]
    buffer_load_dwordx4 a[16:19], v14, s[56:59], s23 offen offset:0 sc1
    v_mfma_f32_16x16x32_bf16 v[56:59], v[144:147], v[172:175], v[56:59]
    ds_read_b64 v[208:209], v2 offset:2752
    v_mfma_f32_16x16x32_bf16 v[56:59], v[148:151], v[168:171], v[56:59]
    ds_read_b64 v[210:211], v2 offset:2760
    v_mfma_f32_16x16x32_bf16 v[60:63], v[152:155], v[168:171], v[60:63]
    ds_read_b128 v[84:87], v1 offset:1216
    v_mfma_f32_16x16x32_bf16 v[60:63], v[148:151], v[172:175], v[60:63]
    buffer_load_dwordx4 a[20:23], v14, s[56:59], s23 offen offset:1024 sc1
    v_mfma_f32_16x16x32_bf16 v[60:63], v[144:147], v[176:179], v[60:63]
    ds_read_b64 v[212:213], v2 offset:2240
    v_mfma_f32_16x16x32_bf16 v[60:63], v[140:143], v[180:183], v[60:63]
    ds_read_b64 v[214:215], v2 offset:2248
    v_mfma_f32_16x16x32_bf16 v[60:63], v[136:139], v[184:187], v[60:63]
    ds_read_b128 v[88:91], v1 offset:1728
    v_mfma_f32_16x16x32_bf16 v[64:67], v[136:139], v[188:191], v[64:67]
    buffer_load_dwordx4 a[24:27], v14, s[56:59], s23 offen offset:2048 sc1
    v_mfma_f32_16x16x32_bf16 v[64:67], v[140:143], v[184:187], v[64:67]
    ds_read_b64 v[216:217], v2 offset:1728
    v_mfma_f32_16x16x32_bf16 v[64:67], v[144:147], v[180:183], v[64:67]
    ds_read_b64 v[218:219], v2 offset:1736
    v_mfma_f32_16x16x32_bf16 v[64:67], v[148:151], v[176:179], v[64:67]
    ds_read_b128 v[92:95], v1 offset:2240
    v_mfma_f32_16x16x32_bf16 v[64:67], v[152:155], v[172:175], v[64:67]
    buffer_load_dwordx4 a[28:31], v14, s[56:59], s23 offen offset:3072 sc1
    v_mfma_f32_16x16x32_bf16 v[64:67], v[156:159], v[168:171], v[64:67]
    ds_read_b64 v[220:221], v2 offset:1216
    v_mfma_f32_16x16x32_bf16 v[68:71], v[160:163], v[168:171], v[68:71]
    ds_read_b64 v[222:223], v2 offset:1224
    v_mfma_f32_16x16x32_bf16 v[68:71], v[156:159], v[172:175], v[68:71]
    ds_read_b128 v[96:99], v1 offset:2752
    s_add_u32 s23, s23, 4096
    v_mfma_f32_16x16x32_bf16 v[68:71], v[152:155], v[176:179], v[68:71]
    buffer_load_dwordx4 a[32:35], v14, s[56:59], s23 offen offset:0 sc1
    v_mfma_f32_16x16x32_bf16 v[68:71], v[148:151], v[180:183], v[68:71]
    ds_read_b64 v[224:225], v2 offset:704
    v_mfma_f32_16x16x32_bf16 v[68:71], v[144:147], v[184:187], v[68:71]
    ds_read_b64 v[226:227], v2 offset:712
    v_mfma_f32_16x16x32_bf16 v[68:71], v[140:143], v[188:191], v[68:71]
    ds_read_b128 v[100:103], v1 offset:3264
    v_mfma_f32_16x16x32_bf16 v[68:71], v[136:139], v[192:195], v[68:71]
    buffer_load_dwordx4 a[36:39], v14, s[56:59], s23 offen offset:1024 sc1
    v_mfma_f32_16x16x32_bf16 v[72:75], v[136:139], v[196:199], v[72:75]
    ds_read_b64 v[228:229], v2 offset:192
    v_mfma_f32_16x16x32_bf16 v[72:75], v[140:143], v[192:195], v[72:75]
    ds_read_b64 v[230:231], v2 offset:200
    v_mfma_f32_16x16x32_bf16 v[72:75], v[144:147], v[188:191], v[72:75]
    ds_read_b128 v[104:107], v1 offset:3776
    v_mfma_f32_16x16x32_bf16 v[72:75], v[148:151], v[184:187], v[72:75]
    buffer_load_dwordx4 a[40:43], v14, s[56:59], s23 offen offset:2048 sc1
    v_mfma_f32_16x16x32_bf16 v[72:75], v[152:155], v[180:183], v[72:75]
    v_mfma_f32_16x16x32_bf16 v[72:75], v[156:159], v[176:179], v[72:75]
    v_mfma_f32_16x16x32_bf16 v[72:75], v[160:163], v[172:175], v[72:75]
    v_mfma_f32_16x16x32_bf16 v[72:75], v[164:167], v[168:171], v[72:75]
    s_waitcnt lgkmcnt(0)
    v_mfma_f32_16x16x32_bf16 v[44:47], v[76:79], v[200:203], v[44:47]
    buffer_load_dwordx4 a[44:47], v14, s[56:59], s23 offen offset:3072 sc1
    v_mfma_f32_16x16x32_bf16 v[48:51], v[76:79], v[204:207], v[48:51]
    ds_read_b64 v[168:169], v2 offset:3840
    v_mfma_f32_16x16x32_bf16 v[48:51], v[80:83], v[200:203], v[48:51]
    ds_read_b64 v[170:171], v2 offset:3848
    v_mfma_f32_16x16x32_bf16 v[52:55], v[84:87], v[200:203], v[52:55]
    ds_read_b128 v[136:139], v1 offset:256
    s_add_u32 s23, s23, 4096
    v_mfma_f32_16x16x32_bf16 v[52:55], v[80:83], v[204:207], v[52:55]
    buffer_load_dwordx4 a[48:51], v14, s[56:59], s23 offen offset:0 sc1
    v_mfma_f32_16x16x32_bf16 v[52:55], v[76:79], v[208:211], v[52:55]
    ds_read_b64 v[172:173], v2 offset:3328
    v_mfma_f32_16x16x32_bf16 v[56:59], v[76:79], v[212:215], v[56:59]
    ds_read_b64 v[174:175], v2 offset:3336
    v_mfma_f32_16x16x32_bf16 v[56:59], v[80:83], v[208:211], v[56:59]
    ds_read_b128 v[140:143], v1 offset:768
    v_mfma_f32_16x16x32_bf16 v[56:59], v[84:87], v[204:207], v[56:59]
    buffer_load_dwordx4 a[52:55], v14, s[56:59], s23 offen offset:1024 sc1
    v_mfma_f32_16x16x32_bf16 v[56:59], v[88:91], v[200:203], v[56:59]
    ds_read_b64 v[176:177], v2 offset:2816
    v_mfma_f32_16x16x32_bf16 v[60:63], v[92:95], v[200:203], v[60:63]
    ds_read_b64 v[178:179], v2 offset:2824
    v_mfma_f32_16x16x32_bf16 v[60:63], v[88:91], v[204:207], v[60:63]
    ds_read_b128 v[144:147], v1 offset:1280
    v_mfma_f32_16x16x32_bf16 v[60:63], v[84:87], v[208:211], v[60:63]
    buffer_load_dwordx4 a[56:59], v14, s[56:59], s23 offen offset:2048 sc1
    v_mfma_f32_16x16x32_bf16 v[60:63], v[80:83], v[212:215], v[60:63]
    ds_read_b64 v[180:181], v2 offset:2304
    v_mfma_f32_16x16x32_bf16 v[60:63], v[76:79], v[216:219], v[60:63]
    ds_read_b64 v[182:183], v2 offset:2312
    v_mfma_f32_16x16x32_bf16 v[64:67], v[76:79], v[220:223], v[64:67]
    ds_read_b128 v[148:151], v1 offset:1792
    v_mfma_f32_16x16x32_bf16 v[64:67], v[80:83], v[216:219], v[64:67]
    buffer_load_dwordx4 a[60:63], v14, s[56:59], s23 offen offset:3072 sc1
    v_mfma_f32_16x16x32_bf16 v[64:67], v[84:87], v[212:215], v[64:67]
    ds_read_b64 v[184:185], v2 offset:1792
    v_mfma_f32_16x16x32_bf16 v[64:67], v[88:91], v[208:211], v[64:67]
    ds_read_b64 v[186:187], v2 offset:1800
    v_mfma_f32_16x16x32_bf16 v[64:67], v[92:95], v[204:207], v[64:67]
    ds_read_b128 v[152:155], v1 offset:2304
    s_add_u32 s23, s23, 4096
    v_mfma_f32_16x16x32_bf16 v[64:67], v[96:99], v[200:203], v[64:67]
    buffer_load_dwordx4 a[64:67], v14, s[56:59], s23 offen offset:0 sc1
    v_mfma_f32_16x16x32_bf16 v[68:71], v[100:103], v[200:203], v[68:71]
    ds_read_b64 v[188:189], v2 offset:1280
    v_mfma_f32_16x16x32_bf16 v[68:71], v[96:99], v[204:207], v[68:71]
    ds_read_b64 v[190:191], v2 offset:1288
    v_mfma_f32_16x16x32_bf16 v[68:71], v[92:95], v[208:211], v[68:71]
    ds_read_b128 v[156:159], v1 offset:2816
    v_mfma_f32_16x16x32_bf16 v[68:71], v[88:91], v[212:215], v[68:71]
    buffer_load_dwordx4 a[68:71], v14, s[56:59], s23 offen offset:1024 sc1
    v_mfma_f32_16x16x32_bf16 v[68:71], v[84:87], v[216:219], v[68:71]
    ds_read_b64 v[192:193], v2 offset:768
    v_mfma_f32_16x16x32_bf16 v[68:71], v[80:83], v[220:223], v[68:71]
    ds_read_b64 v[194:195], v2 offset:776
    v_mfma_f32_16x16x32_bf16 v[68:71], v[76:79], v[224:227], v[68:71]
    ds_read_b128 v[160:163], v1 offset:3328
    v_mfma_f32_16x16x32_bf16 v[72:75], v[76:79], v[228:231], v[72:75]
    ds_read_b64 v[196:197], v2 offset:256
    v_mfma_f32_16x16x32_bf16 v[72:75], v[80:83], v[224:227], v[72:75]
    buffer_load_dwordx4 a[72:75], v14, s[56:59], s23 offen offset:2048 sc1
    v_mfma_f32_16x16x32_bf16 v[72:75], v[84:87], v[220:223], v[72:75]
    ds_read_b64 v[198:199], v2 offset:264
    v_mfma_f32_16x16x32_bf16 v[72:75], v[88:91], v[216:219], v[72:75]
    ds_read_b128 v[164:167], v1 offset:3840
    v_mfma_f32_16x16x32_bf16 v[72:75], v[92:95], v[212:215], v[72:75]
    v_mfma_f32_16x16x32_bf16 v[72:75], v[96:99], v[208:211], v[72:75]
    buffer_load_dwordx4 a[76:79], v14, s[56:59], s23 offen offset:3072 sc1
    v_mfma_f32_16x16x32_bf16 v[72:75], v[100:103], v[204:207], v[72:75]
    v_mfma_f32_16x16x32_bf16 v[72:75], v[104:107], v[200:203], v[72:75]
    s_waitcnt lgkmcnt(0)
    v_mfma_f32_16x16x32_bf16 v[44:47], v[136:139], v[168:171], v[44:47]
    ds_read_b64 v[200:201], v2 offset:3904
    s_add_u32 s23, s23, 4096
    v_mfma_f32_16x16x32_bf16 v[48:51], v[136:139], v[172:175], v[48:51]
L_st8:
    s_cbranch_execz L_wb_F
    buffer_load_dwordx4 a[80:83], v14, s[56:59], s23 offen offset:0 sc1
    v_mfma_f32_16x16x32_bf16 v[48:51], v[140:143], v[168:171], v[48:51]
    ds_read_b64 v[202:203], v2 offset:3912
    v_mfma_f32_16x16x32_bf16 v[52:55], v[144:147], v[168:171], v[52:55]
    ds_read_b128 v[76:79], v1 offset:320
    v_mfma_f32_16x16x32_bf16 v[52:55], v[140:143], v[172:175], v[52:55]
    ds_read_b64 v[204:205], v2 offset:3392
    v_mfma_f32_16x16x32_bf16 v[52:55], v[136:139], v[176:179], v[52:55]
    ds_read_b64 v[206:207], v2 offset:3400
    v_mfma_f32_16x16x32_bf16 v[56:59], v[136:139], v[180:183], v[56:59]
    buffer_load_dwordx4 a[84:87], v14, s[56:59], s23 offen offset:1024 sc1
    v_mfma_f32_16x16x32_bf16 v[56:59], v[140:143], v[176:179], v[56:59]
    ds_read_b128 v[80:83], v1 offset:832
    v_mfma_f32_16x16x32_bf16 v[56:59], v[144:147], v[172:175], v[56:59]
    ds_read_b64 v[208:209], v2 offset:2880
    v_mfma_f32_16x16x32_bf16 v[56:59], v[148:151], v[168:171], v[56:59]
    ds_read_b64 v[210:211], v2 offset:2888
    v_mfma_f32_16x16x32_bf16 v[60:63], v[152:155], v[168:171], v[60:63]
    buffer_load_dwordx4 a[88:91], v14, s[56:59], s23 offen offset:2048 sc1
    v_mfma_f32_16x16x32_bf16 v[60:63], v[148:151], v[172:175], v[60:63]
    ds_read_b128 v[84:87], v1 offset:1344
    v_mfma_f32_16x16x32_bf16 v[60:63], v[144:147], v[176:179], v[60:63]
    ds_read_b64 v[212:213], v2 offset:2368
    v_mfma_f32_16x16x32_bf16 v[60:63], v[140:143], v[180:183], v[60:63]
    ds_read_b64 v[214:215], v2 offset:2376
    v_mfma_f32_16x16x32_bf16 v[60:63], v[136:139], v[184:187], v[60:63]
    ds_read_b128 v[88:91], v1 offset:1856
    v_mfma_f32_16x16x32_bf16 v[64:67], v[136:139], v[188:191], v[64:67]
    buffer_load_dwordx4 a[92:95], v14, s[56:59], s23 offen offset:3072 sc1
    v_mfma_f32_16x16x32_bf16 v[64:67], v[140:143], v[184:187], v[64:67]
    ds_read_b64 v[216:217], v2 offset:1856
    v_mfma_f32_16x16x32_bf16 v[64:67], v[144:147], v[180:183], v[64:67]
    ds_read_b64 v[218:219], v2 offset:1864
    v_mfma_f32_16x16x32_bf16 v[64:67], v[148:151], v[176:179], v[64:67]
    ds_read_b128 v[92:95], v1 offset:2368
    s_add_u32 s23, s23, 4096
    v_mfma_f32_16x16x32_bf16 v[64:67], v[152:155], v[172:175], v[64:67]
    buffer_load_dwordx4 a[96:99], v14, s[56:59], s23 offen offset:0 sc1
    v_mfma_f32_16x16x32_bf16 v[64:67], v[156:159], v[168:171], v[64:67]
    ds_read_b64 v[220:221], v2 offset:1344
    v_mfma_f32_16x16x32_bf16 v[68:71], v[160:163], v[168:171], v[68:71]
    ds_read_b64 v[222:223], v2 offset:1352
    v_mfma_f32_16x16x32_bf16 v[68:71], v[156:159], v[172:175], v[68:71]
    ds_read_b128 v[96:99], v1 offset:2880
    v_mfma_f32_16x16x32_bf16 v[68:71], v[152:155], v[176:179], v[68:71]
    ds_read_b64 v[224:225], v2 offset:832
    v_mfma_f32_16x16x32_bf16 v[68:71], v[148:151], v[180:183], v[68:71]
    buffer_load_dwordx4 a[100:103], v14, s[56:59], s23 offen offset:1024 sc1
    v_mfma_f32_16x16x32_bf16 v[68:71], v[144:147], v[184:187], v[68:71]
    ds_read_b64 v[226:227], v2 offset:840
    v_mfma_f32_16x16x32_bf16 v[68:71], v[140:143], v[188:191], v[68:71]
    ds_read_b128 v[100:103], v1 offset:3392
    v_mfma_f32_16x16x32_bf16 v[68:71], v[136:139], v[192:195], v[68:71]
    ds_read_b64 v[228:229], v2 offset:320
    v_mfma_f32_16x16x32_bf16 v[72:75], v[136:139], v[196:199], v[72:75]
    ds_read_b64 v[230:231], v2 offset:328
    v_mfma_f32_16x16x32_bf16 v[72:75], v[140:143], v[192:195], v[72:75]
    buffer_load_dwordx4 a[104:107], v14, s[56:59], s23 offen offset:2048 sc1
    v_mfma_f32_16x16x32_bf16 v[72:75], v[144:147], v[188:191], v[72:75]
    ds_read_b128 v[104:107], v1 offset:3904
    v_mfma_f32_16x16x32_bf16 v[72:75], v[148:151], v[184:187], v[72:75]
    v_mfma_f32_16x16x32_bf16 v[72:75], v[152:155], v[180:183], v[72:75]
    v_mfma_f32_16x16x32_bf16 v[72:75], v[156:159], v[176:179], v[72:75]
    buffer_load_dwordx4 a[108:111], v14, s[56:59], s23 offen offset:3072 sc1
    v_mfma_f32_16x16x32_bf16 v[72:75], v[160:163], v[172:175], v[72:75]
    v_mfma_f32_16x16x32_bf16 v[72:75], v[164:167], v[168:171], v[72:75]
    s_waitcnt lgkmcnt(0)
    v_mfma_f32_16x16x32_bf16 v[44:47], v[76:79], v[200:203], v[44:47]
    ds_read_b64 v[168:169], v2 offset:3968
    v_mfma_f32_16x16x32_bf16 v[48:51], v[76:79], v[204:207], v[48:51]
    ds_read_b64 v[170:171], v2 offset:3976
    s_add_u32 s23, s23, 40960
    v_mfma_f32_16x16x32_bf16 v[48:51], v[80:83], v[200:203], v[48:51]
    buffer_load_dwordx4 v[232:235], v15, s[56:59], s23 offen offset:0 sc1
    v_mfma_f32_16x16x32_bf16 v[52:55], v[84:87], v[200:203], v[52:55]
    ds_read_b128 v[136:139], v1 offset:384
    v_mfma_f32_16x16x32_bf16 v[52:55], v[80:83], v[204:207], v[52:55]
    ds_read_b64 v[172:173], v2 offset:3456
    v_mfma_f32_16x16x32_bf16 v[52:55], v[76:79], v[208:211], v[52:55]
    ds_read_b64 v[174:175], v2 offset:3464
    v_mfma_f32_16x16x32_bf16 v[56:59], v[76:79], v[212:215], v[56:59]
    buffer_load_dwordx4 v[236:239], v15, s[56:59], s23 offen offset:1024 sc1
    v_mfma_f32_16x16x32_bf16 v[56:59], v[80:83], v[208:211], v[56:59]
    ds_read_b128 v[140:143], v1 offset:896
    v_mfma_f32_16x16x32_bf16 v[56:59], v[84:87], v[204:207], v[56:59]
    ds_read_b64 v[176:177], v2 offset:2944
    v_mfma_f32_16x16x32_bf16 v[56:59], v[88:91], v[200:203], v[56:59]
    ds_read_b64 v[178:179], v2 offset:2952
    v_mfma_f32_16x16x32_bf16 v[60:63], v[92:95], v[200:203], v[60:63]
    ds_read_b128 v[144:147], v1 offset:1408
    v_mfma_f32_16x16x32_bf16 v[60:63], v[88:91], v[204:207], v[60:63]
    buffer_load_dwordx4 v[240:243], v15, s[56:59], s23 offen offset:2048 sc1
    v_mfma_f32_16x16x32_bf16 v[60:63], v[84:87], v[208:211], v[60:63]
    ds_read_b64 v[180:181], v2 offset:2432
    v_mfma_f32_16x16x32_bf16 v[60:63], v[80:83], v[212:215], v[60:63]
    ds_read_b64 v[182:183], v2 offset:2440
    v_mfma_f32_16x16x32_bf16 v[60:63], v[76:79], v[216:219], v[60:63]
    ds_read_b128 v[148:151], v1 offset:1920
    v_mfma_f32_16x16x32_bf16 v[64:67], v[76:79], v[220:223], v[64:67]
    ds_read_b64 v[184:185], v2 offset:1920
    v_mfma_f32_16x16x32_bf16 v[64:67], v[80:83], v[216:219], v[64:67]
    buffer_load_dwordx4 v[244:247], v15, s[56:59], s23 offen offset:3072 sc1
    v_mfma_f32_16x16x32_bf16 v[64:67], v[84:87], v[212:215], v[64:67]
    ds_read_b64 v[186:187], v2 offset:1928
    v_mfma_f32_16x16x32_bf16 v[64:67], v[88:91], v[208:211], v[64:67]
    ds_read_b128 v[152:155], v1 offset:2432
    v_mfma_f32_16x16x32_bf16 v[64:67], v[92:95], v[204:207], v[64:67]
    ds_read_b64 v[188:189], v2 offset:1408
    s_add_u32 s23, s23, 4096
    v_mfma_f32_16x16x32_bf16 v[64:67], v[96:99], v[200:203], v[64:67]
    buffer_load_dwordx4 v[248:251], v15, s[56:59], s23 offen offset:0 sc1
    v_mfma_f32_16x16x32_bf16 v[68:71], v[100:103], v[200:203], v[68:71]
    ds_read_b64 v[190:191], v2 offset:1416
    v_mfma_f32_16x16x32_bf16 v[68:71], v[96:99], v[204:207], v[68:71]
    ds_read_b128 v[156:159], v1 offset:2944
    v_mfma_f32_16x16x32_bf16 v[68:71], v[92:95], v[208:211], v[68:71]
    ds_read_b64 v[192:193], v2 offset:896
    v_mfma_f32_16x16x32_bf16 v[68:71], v[88:91], v[212:215], v[68:71]
    ds_read_b64 v[194:195], v2 offset:904
    v_mfma_f32_16x16x32_bf16 v[68:71], v[84:87], v[216:219], v[68:71]
    buffer_load_dwordx4 v[252:255], v15, s[56:59], s23 offen offset:1024 sc1
    v_mfma_f32_16x16x32_bf16 v[68:71], v[80:83], v[220:223], v[68:71]
    ds_read_b128 v[160:163], v1 offset:3456
    v_mfma_f32_16x16x32_bf16 v[68:71], v[76:79], v[224:227], v[68:71]
    ds_read_b64 v[196:197], v2 offset:384
    v_mfma_f32_16x16x32_bf16 v[72:75], v[76:79], v[228:231], v[72:75]
    ds_read_b64 v[198:199], v2 offset:392
    s_add_u32 m0, s93, 0
    v_mfma_f32_16x16x32_bf16 v[72:75], v[80:83], v[224:227], v[72:75]
    buffer_load_dwordx4 v24, s[28:31], 0 offen lds
    v_mfma_f32_16x16x32_bf16 v[72:75], v[84:87], v[220:223], v[72:75]
    ds_read_b128 v[164:167], v1 offset:3968
    v_mfma_f32_16x16x32_bf16 v[72:75], v[88:91], v[216:219], v[72:75]
    v_mfma_f32_16x16x32_bf16 v[72:75], v[92:95], v[212:215], v[72:75]
    v_mfma_f32_16x16x32_bf16 v[72:75], v[96:99], v[208:211], v[72:75]
    s_add_u32 m0, s93, 1024
    v_mfma_f32_16x16x32_bf16 v[72:75], v[100:103], v[204:207], v[72:75]
    buffer_load_dwordx4 v25, s[28:31], 0 offen lds
    v_mfma_f32_16x16x32_bf16 v[72:75], v[104:107], v[200:203], v[72:75]
    s_waitcnt lgkmcnt(0)
    v_mfma_f32_16x16x32_bf16 v[44:47], v[136:139], v[168:171], v[44:47]
    ds_read_b64 v[200:201], v2 offset:4032
    v_mfma_f32_16x16x32_bf16 v[48:51], v[136:139], v[172:175], v[48:51]
    ds_read_b64 v[202:203], v2 offset:4040
    s_add_u32 m0, s93, 2048
    v_mfma_f32_16x16x32_bf16 v[48:51], v[140:143], v[168:171], v[48:51]
    buffer_load_dwordx4 v26, s[28:31], 0 offen lds
    v_mfma_f32_16x16x32_bf16 v[52:55], v[144:147], v[168:171], v[52:55]
    ds_read_b128 v[76:79], v1 offset:448
    v_mfma_f32_16x16x32_bf16 v[52:55], v[140:143], v[172:175], v[52:55]
    ds_read_b64 v[204:205], v2 offset:3520
    v_mfma_f32_16x16x32_bf16 v[52:55], v[136:139], v[176:179], v[52:55]
    ds_read_b64 v[206:207], v2 offset:3528
    v_mfma_f32_16x16x32_bf16 v[56:59], v[136:139], v[180:183], v[56:59]
    ds_read_b128 v[80:83], v1 offset:960
    v_mfma_f32_16x16x32_bf16 v[56:59], v[140:143], v[176:179], v[56:59]
    ds_read_b64 v[208:209], v2 offset:3008
    v_mfma_f32_16x16x32_bf16 v[56:59], v[144:147], v[172:175], v[56:59]
    ds_read_b64 v[210:211], v2 offset:3016
    v_mfma_f32_16x16x32_bf16 v[56:59], v[148:151], v[168:171], v[56:59]
    ds_read_b128 v[84:87], v1 offset:1472
    v_mfma_f32_16x16x32_bf16 v[60:63], v[152:155], v[168:171], v[60:63]
    ds_read_b64 v[212:213], v2 offset:2496
    v_mfma_f32_16x16x32_bf16 v[60:63], v[148:151], v[172:175], v[60:63]
    ds_read_b64 v[214:215], v2 offset:2504
    v_mfma_f32_16x16x32_bf16 v[60:63], v[144:147], v[176:179], v[60:63]
    buffer_load_dword v34, v30, s[56:59], s20 offen sc1
    v_mfma_f32_16x16x32_bf16 v[60:63], v[140:143], v[180:183], v[60:63]
    ds_read_b128 v[88:91], v1 offset:1984
    v_mfma_f32_16x16x32_bf16 v[60:63], v[136:139], v[184:187], v[60:63]
    ds_read_b64 v[216:217], v2 offset:1984
    v_mfma_f32_16x16x32_bf16 v[64:67], v[136:139], v[188:191], v[64:67]
    ds_read_b64 v[218:219], v2 offset:1992
    v_mfma_f32_16x16x32_bf16 v[64:67], v[140:143], v[184:187], v[64:67]
    ds_read_b128 v[92:95], v1 offset:2496
    v_mfma_f32_16x16x32_bf16 v[64:67], v[144:147], v[180:183], v[64:67]
    ds_read_b64 v[220:221], v2 offset:1472
    v_mfma_f32_16x16x32_bf16 v[64:67], v[148:151], v[176:179], v[64:67]
    ds_read_b64 v[222:223], v2 offset:1480
    v_mfma_f32_16x16x32_bf16 v[64:67], v[152:155], v[172:175], v[64:67]
    ds_read_b128 v[96:99], v1 offset:3008
    v_mfma_f32_16x16x32_bf16 v[64:67], v[156:159], v[168:171], v[64:67]
    ds_read_b64 v[224:225], v2 offset:960
    v_mfma_f32_16x16x32_bf16 v[68:71], v[160:163], v[168:171], v[68:71]
    ds_read_b64 v[226:227], v2 offset:968
    v_mfma_f32_16x16x32_bf16 v[68:71], v[156:159], v[172:175], v[68:71]
    ds_read_b128 v[100:103], v1 offset:3520
    v_mfma_f32_16x16x32_bf16 v[68:71], v[152:155], v[176:179], v[68:71]
    ds_read_b64 v[228:229], v2 offset:448
    v_mfma_f32_16x16x32_bf16 v[68:71], v[148:151], v[180:183], v[68:71]
    ds_read_b64 v[230:231], v2 offset:456
    v_mfma_f32_16x16x32_bf16 v[68:71], v[144:147], v[184:187], v[68:71]
    ds_read_b128 v[104:107], v1 offset:4032
    v_mfma_f32_16x16x32_bf16 v[68:71], v[140:143], v[188:191], v[68:71]
    v_mfma_f32_16x16x32_bf16 v[68:71], v[136:139], v[192:195], v[68:71]
    v_mfma_f32_16x16x32_bf16 v[72:75], v[136:139], v[196:199], v[72:75]
    v_mfma_f32_16x16x32_bf16 v[72:75], v[140:143], v[192:195], v[72:75]
    v_mfma_f32_16x16x32_bf16 v[72:75], v[144:147], v[188:191], v[72:75]
    v_mfma_f32_16x16x32_bf16 v[72:75], v[148:151], v[184:187], v[72:75]
    v_mfma_f32_16x16x32_bf16 v[72:75], v[152:155], v[180:183], v[72:75]
    v_mfma_f32_16x16x32_bf16 v[72:75], v[156:159], v[176:179], v[72:75]
    v_mfma_f32_16x16x32_bf16 v[72:75], v[160:163], v[172:175], v[72:75]
    v_mfma_f32_16x16x32_bf16 v[72:75], v[164:167], v[168:171], v[72:75]
    s_waitcnt lgkmcnt(0)
    v_mfma_f32_16x16x32_bf16 v[44:47], v[76:79], v[200:203], v[44:47]
    v_mfma_f32_16x16x32_bf16 v[48:51], v[76:79], v[204:207], v[48:51]
    v_mfma_f32_16x16x32_bf16 v[48:51], v[80:83], v[200:203], v[48:51]
    v_mfma_f32_16x16x32_bf16 v[52:55], v[84:87], v[200:203], v[52:55]
    v_mfma_f32_16x16x32_bf16 v[52:55], v[80:83], v[204:207], v[52:55]
    s_waitcnt vmcnt(0)
    v_cmp_ne_u32 vcc, s65, v34
    s_barrier
    s_cbranch_vccnz L_alt
    v_mfma_f32_16x16x32_bf16 v[52:55], v[76:79], v[208:211], v[52:55]
    v_mfma_f32_16x16x32_bf16 v[56:59], v[76:79], v[212:215], v[56:59]
    buffer_load_dword v12, v28, s[56:59], s92 offen sc1
    v_mfma_f32_16x16x32_bf16 v[56:59], v[80:83], v[208:211], v[56:59]
    v_cvt_pk_bf16_f32 v108, v44, v45
    v_cvt_pk_bf16_f32 v109, v46, v47
    v_mfma_f32_16x16x32_bf16 v[56:59], v[84:87], v[204:207], v[56:59]
    v_cvt_pk_bf16_f32 v132, v48, v49
    v_mfma_f32_16x16x32_bf16 v[56:59], v[88:91], v[200:203], v[56:59]
    v_cvt_pk_bf16_f32 v133, v50, v51
    v_cvt_pk_bf16_f32 v110, v48, v49
    buffer_load_dwordx4 v[136:139], v14, s[56:59], s24 offen offset:0 sc1
    v_mfma_f32_16x16x32_bf16 v[60:63], v[92:95], v[200:203], v[60:63]
    v_cvt_pk_bf16_f32 v111, v50, v51
    v_mfma_f32_16x16x32_bf16 v[60:63], v[88:91], v[204:207], v[60:63]
    s_nop 0
    v_mfma_f32_16x16x32_bf16 v[60:63], v[84:87], v[208:211], v[60:63]
    v_mov_b32_dpp v110, v108 row_ror:8 row_mask:0xf bank_mask:0x3
    v_mov_b32_dpp v111, v109 row_ror:8 row_mask:0xf bank_mask:0x3
    v_mfma_f32_16x16x32_bf16 v[60:63], v[80:83], v[212:215], v[60:63]
    v_mov_b32_dpp v108, v132 row_ror:8 row_mask:0xf bank_mask:0xc
    buffer_load_dwordx4 v[140:143], v14, s[56:59], s24 offen offset:1024 sc1
    v_mfma_f32_16x16x32_bf16 v[60:63], v[76:79], v[216:219], v[60:63]
    v_mov_b32_dpp v109, v133 row_ror:8 row_mask:0xf bank_mask:0xc
    v_mfma_f32_16x16x32_bf16 v[64:67], v[76:79], v[220:223], v[64:67]
    v_cvt_pk_bf16_f32 v112, v52, v53
    v_cvt_pk_bf16_f32 v113, v54, v55
    v_mfma_f32_16x16x32_bf16 v[64:67], v[80:83], v[216:219], v[64:67]
    v_cvt_pk_bf16_f32 v132, v56, v57
    buffer_load_dwordx4 v[144:147], v14, s[56:59], s24 offen offset:2048 sc1
    v_mfma_f32_16x16x32_bf16 v[64:67], v[84:87], v[212:215], v[64:67]
    v_cvt_pk_bf16_f32 v133, v58, v59
    v_cvt_pk_bf16_f32 v114, v56, v57
    v_mfma_f32_16x16x32_bf16 v[64:67], v[88:91], v[208:211], v[64:67]
    v_cvt_pk_bf16_f32 v115, v58, v59
    v_mfma_f32_16x16x32_bf16 v[64:67], v[92:95], v[204:207], v[64:67]
    s_nop 0
    buffer_load_dwordx4 v[148:151], v14, s[56:59], s24 offen offset:3072 sc1
    v_mfma_f32_16x16x32_bf16 v[64:67], v[96:99], v[200:203], v[64:67]
    v_mov_b32_dpp v114, v112 row_ror:8 row_mask:0xf bank_mask:0x3
    v_mov_b32_dpp v115, v113 row_ror:8 row_mask:0xf bank_mask:0x3
    v_mfma_f32_16x16x32_bf16 v[68:71], v[100:103], v[200:203], v[68:71]
    v_mov_b32_dpp v112, v132 row_ror:8 row_mask:0xf bank_mask:0xc
    v_mfma_f32_16x16x32_bf16 v[68:71], v[96:99], v[204:207], v[68:71]
    v_mov_b32_dpp v113, v133 row_ror:8 row_mask:0xf bank_mask:0xc
    s_add_u32 s24, s24, 4096
    v_mfma_f32_16x16x32_bf16 v[68:71], v[92:95], v[208:211], v[68:71]
    buffer_load_dwordx4 v[152:155], v14, s[56:59], s24 offen offset:0 sc1
    v_mfma_f32_16x16x32_bf16 v[68:71], v[88:91], v[212:215], v[68:71]
    v_mfma_f32_16x16x32_bf16 v[68:71], v[84:87], v[216:219], v[68:71]
    v_cvt_pk_bf16_f32 v116, v60, v61
    v_cvt_pk_bf16_f32 v117, v62, v63
    v_mfma_f32_16x16x32_bf16 v[68:71], v[80:83], v[220:223], v[68:71]
    v_cvt_pk_bf16_f32 v132, v64, v65
    buffer_load_dwordx4 v[156:159], v14, s[56:59], s24 offen offset:1024 sc1
    v_mfma_f32_16x16x32_bf16 v[68:71], v[76:79], v[224:227], v[68:71]
    v_cvt_pk_bf16_f32 v133, v66, v67
    v_mfma_f32_16x16x32_bf16 v[72:75], v[76:79], v[228:231], v[72:75]
    v_cvt_pk_bf16_f32 v118, v64, v65
    v_mfma_f32_16x16x32_bf16 v[72:75], v[80:83], v[224:227], v[72:75]
    v_cvt_pk_bf16_f32 v119, v66, v67
    v_mfma_f32_16x16x32_bf16 v[72:75], v[84:87], v[220:223], v[72:75]
    s_nop 0
    buffer_load_dwordx4 v[160:163], v14, s[56:59], s24 offen offset:2048 sc1
    v_mfma_f32_16x16x32_bf16 v[72:75], v[88:91], v[216:219], v[72:75]
    v_mov_b32_dpp v118, v116 row_ror:8 row_mask:0xf bank_mask:0x3
    v_mfma_f32_16x16x32_bf16 v[72:75], v[92:95], v[212:215], v[72:75]
    v_mov_b32_dpp v119, v117 row_ror:8 row_mask:0xf bank_mask:0x3
    v_mfma_f32_16x16x32_bf16 v[72:75], v[96:99], v[208:211], v[72:75]
    v_mov_b32_dpp v116, v132 row_ror:8 row_mask:0xf bank_mask:0xc
    buffer_load_dwordx4 v[164:167], v14, s[56:59], s24 offen offset:3072 sc1
    v_mfma_f32_16x16x32_bf16 v[72:75], v[100:103], v[204:207], v[72:75]
    v_mov_b32_dpp v117, v133 row_ror:8 row_mask:0xf bank_mask:0xc
    v_mfma_f32_16x16x32_bf16 v[72:75], v[104:107], v[200:203], v[72:75]
    buffer_store_dwordx4 v[108:111], v13, s[56:59], s90 offen offset:0 sc1
    buffer_store_dwordx4 v[112:115], v13, s[56:59], s90 offen offset:1024 sc1
    buffer_store_dwordx4 v[116:119], v13, s[56:59], s90 offen offset:2048 sc1
    v_cvt_pk_bf16_f32 v120, v68, v69
    v_cvt_pk_bf16_f32 v121, v70, v71
    s_nop 2
    v_cvt_pk_bf16_f32 v132, v72, v73
    v_cvt_pk_bf16_f32 v133, v74, v75
    v_cvt_pk_bf16_f32 v122, v72, v73
    v_cvt_pk_bf16_f32 v123, v74, v75
    s_nop 0
    v_mov_b32_dpp v122, v120 row_ror:8 row_mask:0xf bank_mask:0x3
    v_mov_b32_dpp v123, v121 row_ror:8 row_mask:0xf bank_mask:0x3
    v_mov_b32_dpp v120, v132 row_ror:8 row_mask:0xf bank_mask:0xc
    v_mov_b32_dpp v121, v133 row_ror:8 row_mask:0xf bank_mask:0xc
    buffer_store_dwordx4 v[120:123], v13, s[56:59], s90 offen offset:3072 sc1
    s_branch L_shared
L_alt:
    v_mfma_f32_16x16x32_bf16 v[52:55], v[76:79], v[208:211], v[52:55]
    v_mfma_f32_16x16x32_bf16 v[56:59], v[76:79], v[212:215], v[56:59]
    v_mfma_f32_16x16x32_bf16 v[56:59], v[80:83], v[208:211], v[56:59]
    v_cvt_pk_bf16_f32 v108, v44, v45
    v_cvt_pk_bf16_f32 v109, v46, v47
    v_mfma_f32_16x16x32_bf16 v[56:59], v[84:87], v[204:207], v[56:59]
    v_cvt_pk_bf16_f32 v132, v48, v49
    v_mfma_f32_16x16x32_bf16 v[56:59], v[88:91], v[200:203], v[56:59]
    v_cvt_pk_bf16_f32 v133, v50, v51
    v_cvt_pk_bf16_f32 v110, v48, v49
    v_mfma_f32_16x16x32_bf16 v[60:63], v[92:95], v[200:203], v[60:63]
    v_cvt_pk_bf16_f32 v111, v50, v51
    v_mfma_f32_16x16x32_bf16 v[60:63], v[88:91], v[204:207], v[60:63]
    s_nop 0
    v_mfma_f32_16x16x32_bf16 v[60:63], v[84:87], v[208:211], v[60:63]
    v_mov_b32_dpp v110, v108 row_ror:8 row_mask:0xf bank_mask:0x3
    v_mov_b32_dpp v111, v109 row_ror:8 row_mask:0xf bank_mask:0x3
    v_mfma_f32_16x16x32_bf16 v[60:63], v[80:83], v[212:215], v[60:63]
    v_mov_b32_dpp v108, v132 row_ror:8 row_mask:0xf bank_mask:0xc
    v_mfma_f32_16x16x32_bf16 v[60:63], v[76:79], v[216:219], v[60:63]
    v_mov_b32_dpp v109, v133 row_ror:8 row_mask:0xf bank_mask:0xc
    v_mfma_f32_16x16x32_bf16 v[64:67], v[76:79], v[220:223], v[64:67]
    buffer_load_dword v34, v30, s[56:59], s20 offen sc1
    v_cvt_pk_bf16_f32 v112, v52, v53
    v_cvt_pk_bf16_f32 v113, v54, v55
    v_mfma_f32_16x16x32_bf16 v[64:67], v[80:83], v[216:219], v[64:67]
    v_cvt_pk_bf16_f32 v132, v56, v57
    v_mfma_f32_16x16x32_bf16 v[64:67], v[84:87], v[212:215], v[64:67]
    v_cvt_pk_bf16_f32 v133, v58, v59
    v_cvt_pk_bf16_f32 v114, v56, v57
    v_mfma_f32_16x16x32_bf16 v[64:67], v[88:91], v[208:211], v[64:67]
    v_cvt_pk_bf16_f32 v115, v58, v59
    v_mfma_f32_16x16x32_bf16 v[64:67], v[92:95], v[204:207], v[64:67]
    s_nop 0
    v_mfma_f32_16x16x32_bf16 v[64:67], v[96:99], v[200:203], v[64:67]
    v_mov_b32_dpp v114, v112 row_ror:8 row_mask:0xf bank_mask:0x3
    v_mov_b32_dpp v115, v113 row_ror:8 row_mask:0xf bank_mask:0x3
    v_mfma_f32_16x16x32_bf16 v[68:71], v[100:103], v[200:203], v[68:71]
    v_mov_b32_dpp v112, v132 row_ror:8 row_mask:0xf bank_mask:0xc
    v_mfma_f32_16x16x32_bf16 v[68:71], v[96:99], v[204:207], v[68:71]
    v_mov_b32_dpp v113, v133 row_ror:8 row_mask:0xf bank_mask:0xc
    v_mfma_f32_16x16x32_bf16 v[68:71], v[92:95], v[208:211], v[68:71]
    v_mfma_f32_16x16x32_bf16 v[68:71], v[88:91], v[212:215], v[68:71]
    v_mfma_f32_16x16x32_bf16 v[68:71], v[84:87], v[216:219], v[68:71]
    v_cvt_pk_bf16_f32 v116, v60, v61
    v_cvt_pk_bf16_f32 v117, v62, v63
    v_mfma_f32_16x16x32_bf16 v[68:71], v[80:83], v[220:223], v[68:71]
    v_cvt_pk_bf16_f32 v132, v64, v65
    v_mfma_f32_16x16x32_bf16 v[68:71], v[76:79], v[224:227], v[68:71]
    v_cvt_pk_bf16_f32 v133, v66, v67
    v_mfma_f32_16x16x32_bf16 v[72:75], v[76:79], v[228:231], v[72:75]
    v_cvt_pk_bf16_f32 v118, v64, v65
    v_mfma_f32_16x16x32_bf16 v[72:75], v[80:83], v[224:227], v[72:75]
    v_cvt_pk_bf16_f32 v119, v66, v67
    v_mfma_f32_16x16x32_bf16 v[72:75], v[84:87], v[220:223], v[72:75]
    s_nop 0
    v_mfma_f32_16x16x32_bf16 v[72:75], v[88:91], v[216:219], v[72:75]
    v_mov_b32_dpp v118, v116 row_ror:8 row_mask:0xf bank_mask:0x3
    v_mfma_f32_16x16x32_bf16 v[72:75], v[92:95], v[212:215], v[72:75]
    v_mov_b32_dpp v119, v117 row_ror:8 row_mask:0xf bank_mask:0x3
    v_mfma_f32_16x16x32_bf16 v[72:75], v[96:99], v[208:211], v[72:75]
    v_mov_b32_dpp v116, v132 row_ror:8 row_mask:0xf bank_mask:0xc
    v_mfma_f32_16x16x32_bf16 v[72:75], v[100:103], v[204:207], v[72:75]
    v_mov_b32_dpp v117, v133 row_ror:8 row_mask:0xf bank_mask:0xc
    v_mfma_f32_16x16x32_bf16 v[72:75], v[104:107], v[200:203], v[72:75]
    buffer_store_dwordx4 v[108:111], v13, s[56:59], s90 offen offset:0 sc1
    buffer_store_dwordx4 v[112:115], v13, s[56:59], s90 offen offset:1024 sc1
    buffer_store_dwordx4 v[116:119], v13, s[56:59], s90 offen offset:2048 sc1
    v_cvt_pk_bf16_f32 v120, v68, v69
    v_cvt_pk_bf16_f32 v121, v70, v71
    s_nop 2
    v_cvt_pk_bf16_f32 v132, v72, v73
    v_cvt_pk_bf16_f32 v133, v74, v75
    v_cvt_pk_bf16_f32 v122, v72, v73
    v_cvt_pk_bf16_f32 v123, v74, v75
    s_nop 0
    v_mov_b32_dpp v122, v120 row_ror:8 row_mask:0xf bank_mask:0x3
    v_mov_b32_dpp v123, v121 row_ror:8 row_mask:0xf bank_mask:0x3
    v_mov_b32_dpp v120, v132 row_ror:8 row_mask:0xf bank_mask:0xc
    v_mov_b32_dpp v121, v133 row_ror:8 row_mask:0xf bank_mask:0xc
    buffer_store_dwordx4 v[120:123], v13, s[56:59], s90 offen offset:3072 sc1
    v_bfrev_b32 v33, 1
    s_waitcnt vmcnt(4)
    v_cmp_ne_u32 vcc, s65, v34
    s_cbranch_vccnz L_spin15
L_ok16:
    buffer_load_dword v12, v28, s[56:59], s92 offen sc1
    buffer_load_dwordx4 v[136:139], v14, s[56:59], s24 offen offset:0 sc1
    buffer_load_dwordx4 v[140:143], v14, s[56:59], s24 offen offset:1024 sc1
    buffer_load_dwordx4 v[144:147], v14, s[56:59], s24 offen offset:2048 sc1
    buffer_load_dwordx4 v[148:151], v14, s[56:59], s24 offen offset:3072 sc1
    s_add_u32 s24, s24, 4096
    buffer_load_dwordx4 v[152:155], v14, s[56:59], s24 offen offset:0 sc1
    buffer_load_dwordx4 v[156:159], v14, s[56:59], s24 offen offset:1024 sc1
    buffer_load_dwordx4 v[160:163], v14, s[56:59], s24 offen offset:2048 sc1
    buffer_load_dwordx4 v[164:167], v14, s[56:59], s24 offen offset:3072 sc1
    buffer_store_dword v19, v33, s[56:59], 0 offen
    buffer_store_dword v19, v33, s[56:59], 0 offen
    buffer_store_dword v19, v33, s[56:59], 0 offen
    buffer_store_dword v19, v33, s[56:59], 0 offen
    s_branch L_shared
L_roleR:
    s_lshr_b32 s77, s67, 2
    s_mul_i32 s7, s68, 8
    s_add_u32 s77, s77, s7
    s_mul_i32 s93, s64, 3072
    s_mul_i32 s6, s77, 81920
    s_mul_i32 s7, s64, 20480
    s_add_u32 s6, s6, s7
    s_mul_i32 s7, s78, 160
    s_add_u32 s6, s6, s7
    v_add_u32 v33, 0, v0
    v_mul_u32_u24 v35, 6554, v33
    v_lshrrev_b32 v35, 16, v35
    v_mul_u32_u24 v35, 1120, v35
    v_lshl_add_u32 v35, v33, 4, v35
    v_add_u32 v24, s6, v35
    v_add_u32 v33, 64, v0
    v_mul_u32_u24 v35, 6554, v33
    v_lshrrev_b32 v35, 16, v35
    v_mul_u32_u24 v35, 1120, v35
    v_lshl_add_u32 v35, v33, 4, v35
    v_add_u32 v25, s6, v35
    v_add_u32 v33, 128, v0
    v_mul_u32_u24 v35, 6554, v33
    v_lshrrev_b32 v35, 16, v35
    v_mul_u32_u24 v35, 1120, v35
    v_lshl_add_u32 v35, v33, 4, v35
    v_add_u32 v26, s6, v35
    v_lshrrev_b32 v33, 5, v0
    v_lshl_or_b32 v26, v33, 31, v26
    v_and_b32 v33, 15, v0
    v_lshrrev_b32 v34, 4, v0
    s_lshr_b32 s4, s64, 1
    s_and_b32 s6, s4, s64
    v_lshl_or_b32 v15, s6, 31, v14
    s_mul_i32 s6, s78, 427
    s_lshr_b32 s6, s6, 5
    v_min_u32 v29, 13, v0
    v_add_u32 v29, s6, v29
    v_min_u32 v29, 106, v29
    v_lshlrev_b32 v29, 6, v29
    s_mov_b32 s21, 65536
    s_lshr_b32 s6, s77, 1
    s_mul_i32 s20, s6, 1024
    s_add_u32 s20, s20, 32768
    s_mul_i32 s6, s64, 19
    s_lshr_b32 s6, s6, 3
    v_min_u32 v30, 2, v0
    v_add_u32 v30, s6, v30
    v_min_u32 v30, 8, v30
    v_lshlrev_b32 v30, 6, v30
    s_mul_i32 s4, s77, 229376
    s_mul_i32 s7, s64, 14336
    s_add_u32 s4, s4, s7
    s_add_u32 s4, s4, 7831552
    s_add_u32 s6, s64, 1
    s_and_b32 s6, s6, 3
    s_mul_i32 s84, s6, 15360
    s_add_u32 s84, s84, 12288
    s_mul_i32 s24, s6, 57344
    s_add_u32 s24, s24, s4
    s_add_u32 s6, s64, 2
    s_and_b32 s6, s6, 3
    s_mul_i32 s85, s6, 15360
    s_add_u32 s85, s85, 17408
    s_mul_i32 s25, s6, 57344
    s_add_u32 s25, s25, s4
    s_add_u32 s6, s64, 3
    s_and_b32 s6, s6, 3
    s_mul_i32 s86, s6, 15360
    s_add_u32 s86, s86, 22528
    s_mul_i32 s26, s6, 57344
    s_add_u32 s26, s26, s4
    s_add_u32 s6, s64, 4
    s_and_b32 s6, s6, 3
    s_mul_i32 s27, s6, 57344
    s_add_u32 s27, s27, s4
    s_mul_i32 s6, s64, 15360
    s_add_u32 s6, s6, 12288
    v_add_u32 v20, s6, v14
    v_add_u32 v23, s93, v14
    v_mul_u32_u24 v21, 160, v33
    v_lshl_add_u32 v21, v34, 3, v21
    v_add_u32 v21, s93, v21
    s_lshr_b32 s6, s64, 1
    s_mul_i32 s6, s6, -120
    s_mul_i32 s7, s64, 64
    s_add_u32 s6, s6, s7
    s_add_u32 s6, s6, 73728
    v_lshrrev_b32 v35, 2, v0
    v_lshlrev_b32 v35, 6, v35
    v_add3_u32 v22, v35, v14, s6
    v_and_b32 v35, 64, v16
    v_xor_b32 v22, v35, v22
    v_and_b32 v35, 64, v31
    v_xor_b32 v27, v35, v27
    s_mul_i32 s94, s64, 1024
    s_add_u32 s94, s94, 73728
    s_mul_i32 s95, s78, 337920
    s_mul_i32 s7, s64, 33792
    s_add_u32 s95, s95, s7
    s_mul_i32 s7, s77, 128
    s_add_u32 s95, s95, s7
    s_add_u32 s95, s95, 2916352
    s_mul_i32 s6, s77, 4
    s_add_u32 s6, s6, s64
    s_lshr_b32 s92, s6, 3
    s_mul_i32 s92, s92, 992
    s_mul_i32 s7, s6, 4
    s_add_u32 s92, s92, s7
    s_add_u32 s92, s92, 16384
    s_add_u32 m0, s93, 0
    s_nop 0
    buffer_load_dwordx4 v24, s[28:31], 0 offen lds
    s_add_u32 m0, s93, 1024
    s_nop 0
    buffer_load_dwordx4 v25, s[28:31], 0 offen lds
    s_add_u32 m0, s93, 2048
    s_nop 0
    buffer_load_dwordx4 v26, s[28:31], 0 offen lds
    s_mul_i32 s4, s64, 1792
    s_add_u32 s4, s4, 49152
    v_min_u32 v5, 27, v0
    v_lshl_add_u32 v5, v5, 6, s4
    buffer_load_dword v34, v5, s[56:59], 0 offen sc1
    s_waitcnt vmcnt(0)
    v_cmp_ne_u32 vcc, s65, v34
    s_cbranch_vccnz L_spin17
L_ok18:
    s_barrier
    buffer_load_dwordx4 a[0:3], v14, s[56:59], s23 offen offset:0 sc1
    buffer_load_dwordx4 a[4:7], v14, s[56:59], s23 offen offset:1024 sc1
    buffer_load_dwordx4 a[8:11], v14, s[56:59], s23 offen offset:2048 sc1
    buffer_load_dwordx4 a[12:15], v14, s[56:59], s23 offen offset:3072 sc1
    s_add_u32 s23, s23, 4096
    buffer_load_dwordx4 a[16:19], v14, s[56:59], s23 offen offset:0 sc1
    buffer_load_dwordx4 a[20:23], v14, s[56:59], s23 offen offset:1024 sc1
    buffer_load_dwordx4 a[24:27], v14, s[56:59], s23 offen offset:2048 sc1
    buffer_load_dwordx4 a[28:31], v14, s[56:59], s23 offen offset:3072 sc1
    s_add_u32 s23, s23, 4096
    buffer_load_dwordx4 a[32:35], v14, s[56:59], s23 offen offset:0 sc1
    buffer_load_dwordx4 a[36:39], v14, s[56:59], s23 offen offset:1024 sc1
    buffer_load_dwordx4 a[40:43], v14, s[56:59], s23 offen offset:2048 sc1
    buffer_load_dwordx4 a[44:47], v14, s[56:59], s23 offen offset:3072 sc1
    s_add_u32 s23, s23, 4096
    buffer_load_dwordx4 a[48:51], v14, s[56:59], s23 offen offset:0 sc1
    buffer_load_dwordx4 a[52:55], v14, s[56:59], s23 offen offset:1024 sc1
    buffer_load_dwordx4 a[56:59], v14, s[56:59], s23 offen offset:2048 sc1
    buffer_load_dwordx4 a[60:63], v14, s[56:59], s23 offen offset:3072 sc1
    s_add_u32 s23, s23, 4096
    buffer_load_dwordx4 a[64:67], v14, s[56:59], s23 offen offset:0 sc1
    buffer_load_dwordx4 a[68:71], v14, s[56:59], s23 offen offset:1024 sc1
    buffer_load_dwordx4 a[72:75], v14, s[56:59], s23 offen offset:2048 sc1
    buffer_load_dwordx4 a[76:79], v14, s[56:59], s23 offen offset:3072 sc1
    s_add_u32 s23, s23, 4096
    buffer_load_dwordx4 a[80:83], v14, s[56:59], s23 offen offset:0 sc1
    buffer_load_dwordx4 a[84:87], v14, s[56:59], s23 offen offset:1024 sc1
    buffer_load_dwordx4 a[88:91], v14, s[56:59], s23 offen offset:2048 sc1
    buffer_load_dwordx4 a[92:95], v14, s[56:59], s23 offen offset:3072 sc1
    s_add_u32 s23, s23, 4096
    buffer_load_dwordx4 a[96:99], v14, s[56:59], s23 offen offset:0 sc1
    buffer_load_dwordx4 a[100:103], v14, s[56:59], s23 offen offset:1024 sc1
    buffer_load_dwordx4 a[104:107], v14, s[56:59], s23 offen offset:2048 sc1
    buffer_load_dwordx4 a[108:111], v14, s[56:59], s23 offen offset:3072 sc1
    s_add_u32 s23, s23, 4096
    buffer_load_dwordx4 a[112:115], v14, s[56:59], s23 offen offset:0 sc1
    buffer_load_dwordx4 a[116:119], v14, s[56:59], s23 offen offset:1024 sc1
    buffer_load_dwordx4 a[120:123], v14, s[56:59], s23 offen offset:2048 sc1
    buffer_load_dwordx4 a[124:127], v14, s[56:59], s23 offen offset:3072 sc1
    s_add_u32 s23, s23, 4096
    buffer_load_dwordx4 a[128:131], v14, s[56:59], s23 offen offset:0 sc1
    buffer_load_dwordx4 a[132:135], v14, s[56:59], s23 offen offset:1024 sc1
    buffer_load_dwordx4 a[136:139], v14, s[56:59], s23 offen offset:2048 sc1
    buffer_load_dwordx4 a[140:143], v14, s[56:59], s23 offen offset:3072 sc1
    s_add_u32 s23, s23, 4096
    buffer_load_dwordx4 a[144:147], v14, s[56:59], s23 offen offset:0 sc1
    buffer_load_dwordx4 a[148:151], v14, s[56:59], s23 offen offset:1024 sc1
    buffer_load_dwordx4 a[152:155], v14, s[56:59], s23 offen offset:2048 sc1
    buffer_load_dwordx4 a[156:159], v14, s[56:59], s23 offen offset:3072 sc1
    s_add_u32 s23, s23, 4096
    buffer_load_dwordx4 a[160:163], v14, s[56:59], s23 offen offset:0 sc1
    buffer_load_dwordx4 a[164:167], v14, s[56:59], s23 offen offset:1024 sc1
    buffer_load_dwordx4 a[168:171], v14, s[56:59], s23 offen offset:2048 sc1
    buffer_load_dwordx4 a[172:175], v14, s[56:59], s23 offen offset:3072 sc1
    s_add_u32 s23, s23, 4096
    buffer_load_dwordx4 a[176:179], v14, s[56:59], s23 offen offset:0 sc1
    buffer_load_dwordx4 a[180:183], v14, s[56:59], s23 offen offset:1024 sc1
    buffer_load_dwordx4 a[184:187], v14, s[56:59], s23 offen offset:2048 sc1
    buffer_load_dwordx4 a[188:191], v14, s[56:59], s23 offen offset:3072 sc1
    s_add_u32 s23, s23, 4096
    buffer_load_dwordx4 a[192:195], v14, s[56:59], s23 offen offset:0 sc1
    buffer_load_dwordx4 a[196:199], v14, s[56:59], s23 offen offset:1024 sc1
    buffer_load_dwordx4 a[200:203], v14, s[56:59], s23 offen offset:2048 sc1
    buffer_load_dwordx4 a[204:207], v14, s[56:59], s23 offen offset:3072 sc1
    s_add_u32 s23, s23, 4096
    buffer_load_dwordx4 a[208:211], v14, s[56:59], s23 offen offset:0 sc1
    buffer_load_dwordx4 a[212:215], v14, s[56:59], s23 offen offset:1024 sc1
    buffer_load_dwordx4 a[216:219], v14, s[56:59], s23 offen offset:2048 sc1
    buffer_load_dwordx4 a[220:223], v14, s[56:59], s23 offen offset:3072 sc1
    s_add_u32 s23, s23, 4096
    buffer_load_dwordx4 a[224:227], v14, s[56:59], s23 offen offset:0 sc1
    buffer_load_dwordx4 a[228:231], v14, s[56:59], s23 offen offset:1024 sc1
    buffer_load_dwordx4 a[232:235], v14, s[56:59], s23 offen offset:2048 sc1
    buffer_load_dwordx4 a[236:239], v14, s[56:59], s23 offen offset:3072 sc1
    s_add_u32 s23, s23, 4096
    buffer_load_dwordx4 a[240:243], v15, s[56:59], s23 offen offset:0 sc1
    buffer_load_dwordx4 a[244:247], v15, s[56:59], s23 offen offset:1024 sc1
    buffer_load_dwordx4 a[248:251], v15, s[56:59], s23 offen offset:2048 sc1
    buffer_load_dwordx4 a[252:255], v15, s[56:59], s23 offen offset:3072 sc1
    s_add_u32 s23, s23, 4096
    buffer_load_dwordx4 v[232:235], v15, s[56:59], s23 offen offset:0 sc1
    buffer_load_dwordx4 v[236:239], v15, s[56:59], s23 offen offset:1024 sc1
    s_cmp_lg_u32 s2, 255
    s_cbranch_scc1 L_noep19
    s_mul_i32 s4, s64, 4096
    s_add_u32 s4, s4, 16416
    v_min_u32 v5, 68, v31
    v_lshrrev_b32 v33, 6, v5
    v_mul_u32_u24 v33, 179200, v33
    v_lshl_add_u32 v5, v5, 4, v33
    v_lshrrev_b32 v33, 5, v0
    v_lshl_add_u32 v5, v33, 11, v5
    v_add_u32 v5, s4, v5
    buffer_load_dword v34, v5, s[56:59], 0 offen sc1
    s_waitcnt vmcnt(0)
    v_cmp_ne_u32 vcc, s65, v34
    s_cbranch_vccnz L_spin20
L_ok21:
    s_barrier
    buffer_store_dword v19, v17, s[56:59], 0 offen sc1
L_noep19:
    v_bfrev_b32 v18, 1
    s_mov_b32 s12, 0
    buffer_load_dword v34, v30, s[56:59], s20 offen sc1
    s_waitcnt vmcnt(0)
    v_cmp_ne_u32 vcc, s65, v34
    s_cbranch_vccnz L_spin22
L_ok23:
    buffer_load_dword v12, v28, s[56:59], s92 offen sc1
    buffer_load_dwordx4 v[136:139], v14, s[56:59], s24 offen offset:0 sc1
    buffer_load_dwordx4 v[140:143], v14, s[56:59], s24 offen offset:1024 sc1
    buffer_load_dwordx4 v[144:147], v14, s[56:59], s24 offen offset:2048 sc1
    buffer_load_dwordx4 v[148:151], v14, s[56:59], s24 offen offset:3072 sc1
    s_add_u32 s24, s24, 4096
    buffer_load_dwordx4 v[152:155], v14, s[56:59], s24 offen offset:0 sc1
    buffer_load_dwordx4 v[156:159], v14, s[56:59], s24 offen offset:1024 sc1
    buffer_load_dwordx4 v[160:163], v14, s[56:59], s24 offen offset:2048 sc1
    buffer_load_dwordx4 v[164:167], v14, s[56:59], s24 offen offset:3072 sc1
    buffer_load_dwordx4 v[240:243], v15, s[56:59], s23 offen offset:2048 sc1
    buffer_load_dwordx4 v[244:247], v15, s[56:59], s23 offen offset:3072 sc1
    s_add_u32 s23, s23, 4096
    buffer_load_dwordx4 v[248:251], v15, s[56:59], s23 offen offset:0 sc1
    buffer_load_dwordx4 v[252:255], v15, s[56:59], s23 offen offset:1024 sc1
    s_branch L_shared
L_spin1:
    buffer_load_dword v252, v255, s[56:59], 0 offen sc1
    s_waitcnt vmcnt(0)
    v_cmp_ne_u32 vcc, s65, v252
    s_cbranch_vccz L_ok2
    s_sleep 4
    s_sub_u32 s8, s8, 1
    s_cbranch_scc0 L_spin1
    s_mov_b32 s8, 0
    s_branch L_ok2
L_spin3:
    buffer_load_dword v252, v253, s[56:59], s91 offen sc1
    s_waitcnt vmcnt(0)
    v_cmp_ne_u32 vcc, s65, v252
    s_and_b32 vcc_lo, vcc_lo, 0xff00ff00
    s_and_b32 vcc_hi, vcc_hi, 0xff00ff00
    s_or_b64 vcc, vcc, 0
    s_cbranch_vccz L_ok4
    s_sleep 4
    s_sub_u32 s8, s8, 1
    s_cbranch_scc0 L_spin3
    s_mov_b32 s8, 0
    s_branch L_ok4
L_spin5:
    buffer_load_dword v34, v30, s[56:59], s20 offen sc1
    s_waitcnt vmcnt(0)
    v_cmp_ne_u32 vcc, s65, v34
    s_cbranch_vccz L_ok6
    s_sleep 4
    s_sub_u32 s8, s8, 1
    s_cbranch_scc0 L_spin5
    s_mov_b32 s8, 0
    s_branch L_ok6
L_spin7:
    buffer_load_dword v34, v29, s[56:59], s21 offen sc1
    s_waitcnt vmcnt(0)
    v_cmp_ne_u32 vcc, s65, v34
    s_cbranch_vccz L_ok8
    s_sleep 4
    s_sub_u32 s8, s8, 1
    s_cbranch_scc0 L_spin7
    s_mov_b32 s8, 0
    s_branch L_ok8
L_spin11:
    buffer_load_dword v9, v5, s[56:59], 0 offen sc1
    s_waitcnt vmcnt(0)
    v_cmp_ne_u32 vcc, s65, v9
    s_cbranch_vccz L_ok12
    s_sleep 4
    s_sub_u32 s8, s8, 1
    s_cbranch_scc0 L_spin11
    s_mov_b32 s8, 0
    s_branch L_ok12
L_spin9:
    buffer_load_dword v12, v10, s[56:59], 0 offen sc1
    s_waitcnt vmcnt(0)
    v_cmp_ne_u32 vcc, s65, v12
    s_cbranch_vccz L_ok10
    s_sleep 4
    s_sub_u32 s8, s8, 1
    s_cbranch_scc0 L_spin9
    s_mov_b32 s8, 0
    s_branch L_ok10
L_spin15:
    buffer_load_dword v34, v30, s[56:59], s20 offen sc1
    s_waitcnt vmcnt(0)
    v_cmp_ne_u32 vcc, s65, v34
    s_cbranch_vccz L_ok16
    s_sleep 4
    s_sub_u32 s8, s8, 1
    s_cbranch_scc0 L_spin15
    s_mov_b32 s8, 0
    s_branch L_ok16
L_spin17:
    buffer_load_dword v34, v5, s[56:59], 0 offen sc1
    s_waitcnt vmcnt(0)
    v_cmp_ne_u32 vcc, s65, v34
    s_cbranch_vccz L_ok18
    s_sleep 4
    s_sub_u32 s8, s8, 1
    s_cbranch_scc0 L_spin17
    s_mov_b32 s8, 0
    s_branch L_ok18
L_spin20:
    buffer_load_dword v34, v5, s[56:59], 0 offen sc1
    s_waitcnt vmcnt(0)
    v_cmp_ne_u32 vcc, s65, v34
    s_cbranch_vccz L_ok21
    s_sleep 4
    s_sub_u32 s8, s8, 1
    s_cbranch_scc0 L_spin20
    s_mov_b32 s8, 0
    s_branch L_ok21
L_spin22:
    buffer_load_dword v34, v30, s[56:59], s20 offen sc1
    s_waitcnt vmcnt(0)
    v_cmp_ne_u32 vcc, s65, v34
    s_cbranch_vccz L_ok23
    s_sleep 4
    s_sub_u32 s8, s8, 1
    s_cbranch_scc0 L_spin22
    s_mov_b32 s8, 0
    s_branch L_ok23
L_end:
    s_endpgm
.section .rodata,"a"
.p2align 6
.amdhsa_kernel parallel_sum__ssm_conv_h3__dense_activation_silu__prompt_kernel
  .amdhsa_next_free_vgpr 512
  .amdhsa_next_free_sgpr 102
  .amdhsa_accum_offset 256
  .amdhsa_group_segment_fixed_size 0
  .amdhsa_kernarg_size 96
  .amdhsa_user_sgpr_count 2
  .amdhsa_user_sgpr_kernarg_segment_ptr 1
  .amdhsa_system_sgpr_workgroup_id_x 1
.end_amdhsa_kernel
```
